```python
import torch

def _softmax(x, axis=-1):
    return torch.softmax(x, dim=axis)
def _gelu(x):
    return torch.nn.functional.gelu(x, approximate="tanh")
def _silu(x):
    return torch.nn.functional.silu(x)
def _sigmoid(x):
    return torch.sigmoid(x)
def _layernorm(x, axis=-1, eps=1e-5):
    m = x.mean(dim=axis, keepdim=True)
    v = x.var(dim=axis, keepdim=True, unbiased=False)
    return (x - m) / torch.sqrt(v + eps)
def _scatter_add(tgt, idx, src, axis=0):
    return tgt.clone().index_add_(axis, idx, src)
def _segment_sum(src, seg, n):
    out = torch.zeros((n,) + src.shape[1:], dtype=src.dtype)
    return out.index_add_(0, seg, src)
def _pad(x, pw):
    flat = tuple(v for pair in reversed(pw) for v in pair)
    return torch.nn.functional.pad(x, flat)

kernel_name = 'recurrent_scan__ssm_conv_s4__moe_arch_mod__prompt'

def setup_inputs():

    _w = (lambda a: (lambda t: t.to(torch.bfloat16) if t.is_floating_point() else t)(torch.as_tensor(a)))
    def _A_setup():
        B, L, D, N = 1, 2048, 512, 128
        A_re = -(lambda _x: torch.exp(torch.as_tensor(_x)))((lambda *s: torch.randn(*s, dtype=torch.bfloat16) * 6.4)(D, N))
        A_im = torch.pi * (lambda *s: torch.randn(*s, dtype=torch.bfloat16) * 0.05)(D, N)
        B_re = (lambda *s: torch.randn(*s, dtype=torch.bfloat16) * 0.2)(D, N)
        B_im = (lambda *s: torch.randn(*s, dtype=torch.bfloat16) * 0.2)(D, N)
        C_re = (lambda *s: torch.randn(*s, dtype=torch.bfloat16) * 0.2)(D, N)
        C_im = (lambda *s: torch.randn(*s, dtype=torch.bfloat16) * 0.2)(D, N)
        log_dt = (lambda *s: torch.randn(*s, dtype=torch.bfloat16) * 0.05)(D) * 0.5 - 4.0
        Dskip = (lambda *s: torch.randn(*s, dtype=torch.bfloat16) * 0.05)(D)
        return {
            "u": _w((lambda *s: torch.randn(*s, dtype=torch.bfloat16) * 0.05)(B, L, D)),
            "A_re": _w(A_re),
            "A_im": _w(A_im),
            "B_re": _w(B_re),
            "B_im": _w(B_im),
            "C_re": _w(C_re),
            "C_im": _w(C_im),
            "log_dt": _w(log_dt),
            "Dskip": _w(Dskip),
        }
    _A_in = _A_setup()

    def _B_setup():
        B, S, D, F, C = 1, 2048, 512, 1376, 2
        return {
            "x": _w((lambda *s: torch.randn(*s, dtype=torch.bfloat16) * 0.05)(B, S, D)),
            "w_r": _w((lambda *s: torch.randn(*s, dtype=torch.bfloat16) * 6.4)(D)),
            "w_gate": _w((lambda *s: torch.randn(*s, dtype=torch.bfloat16) * 0.1)(D, F)),
            "w_up": _w((lambda *s: torch.randn(*s, dtype=torch.bfloat16) * 0.1)(D, F)),
            "w_down": _w((lambda *s: torch.randn(*s, dtype=torch.bfloat16) * 0.1)(F, D)),
        }
    _B_in = _B_setup()

    return {
        "A_u": _A_in["u"],
        "A_A_re": _A_in["A_re"],
        "A_A_im": _A_in["A_im"],
        "A_B_re": _A_in["B_re"],
        "A_B_im": _A_in["B_im"],
        "A_C_re": _A_in["C_re"],
        "A_C_im": _A_in["C_im"],
        "A_log_dt": _A_in["log_dt"],
        "A_Dskip": _A_in["Dskip"],
        "B_x": _B_in["x"],
        "B_w_r": _B_in["w_r"],
        "B_w_gate": _B_in["w_gate"],
        "B_w_up": _B_in["w_up"],
        "B_w_down": _B_in["w_down"],
    }

def reference(A_u, A_A_re, A_A_im, A_B_re, A_B_im, A_C_re, A_C_im, A_log_dt, A_Dskip, B_x, B_w_r, B_w_gate, B_w_up, B_w_down):
    def _A_ref(u, A_re, A_im, B_re, B_im, C_re, C_im, log_dt, Dskip):
        Bsz, L, D = u.shape
        dt = torch.exp(log_dt)[:, None]
        A = A_re + 1j * A_im
        Bc = B_re + 1j * B_im
        Cc = C_re + 1j * C_im
        logdA = dt * A
        dB = dt * Bc
        l = (lambda x, dt: x.to(dt))(torch.arange(L), A_re.dtype)
        P = torch.exp(logdA[:, :, None] * l[None, None, :])
        K = torch.einsum("dn,dnl,dn->dl", Cc, P, dB).real
        L2 = 2 * L
        Kp = _pad(K, ((0, 0), (0, L)))
        up = (lambda x, *d: x.permute(*d))(u, 0, 2, 1)
        up = _pad(up, ((0, 0), (0, 0), (0, L)))
        Kf = (lambda x, axes=(-2,-1): torch.fft.rfft2(x.float(), dim=axes))(Kp[:, None, :], axes=(-2, -1))
        Uf = (lambda x, axes=(-2,-1): torch.fft.rfft2(x.float(), dim=axes))(up[:, :, None, :], axes=(-2, -1))
        Yf = Uf * Kf[None, :, :, :]
        y = (lambda x, s, axes=(-2,-1): torch.fft.irfft2(x, s=s, dim=axes).to(torch.bfloat16))(Yf, (1, L2), axes=(-2, -1))[:, :, 0, :L]
        y = (lambda x, *d: x.permute(*d))(y, 0, 2, 1) + u * Dskip[None, None, :]
        return y

    def _B_ref(x, w_r, w_gate, w_up, w_down):
        B, S, D = x.shape
        C = 2
        r = x @ w_r
        idx = torch.argsort(-r, axis=-1)[:, :C]
        idx_e = (lambda x, n, axis: torch.repeat_interleave(x, n, dim=axis))(idx.reshape(B, C, 1), D, axis=2)
        x_sel = (lambda x, i, axis: torch.take_along_dim(x, i, dim=axis))(x, idx_e, axis=1)
        g = _silu(x_sel @ w_gate)
        u = x_sel @ w_up
        y = (g * u) @ w_down
        r_sel = _sigmoid((lambda x, i, axis: torch.take_along_dim(x, i, dim=axis))(r, idx, axis=1))
        y = y * r_sel.reshape(B, C, 1)
        b_off = (torch.arange(B) * S).reshape(B, 1)
        flat_idx = (idx + b_off).reshape(B * C)
        zero = (x * 0.0).reshape(B * S, D)
        upd = _scatter_add(zero, flat_idx, y.reshape(B * C, D), axis=0)
        return x + upd.reshape(B, S, D)

    x = A_u
    xn = _layernorm(x, axis=-1)
    s = _A_ref(xn, A_A_re, A_A_im, A_B_re, A_B_im, A_C_re, A_C_im, A_log_dt, A_Dskip)
    g = _silu(_B_ref(xn, B_w_r, B_w_gate, B_w_up, B_w_down))
    return x + s * g
```

```asm
; @launch grid=(256,1,1) block=(512,1,1) lds=142336
.amdgcn_target "amdgcn-amd-amdhsa--gfx950"
.text
.globl recurrent_scan__ssm_conv_s4__moe_arch_mod__prompt_kernel
.p2align 8
.type recurrent_scan__ssm_conv_s4__moe_arch_mod__prompt_kernel,@function
recurrent_scan__ssm_conv_s4__moe_arch_mod__prompt_kernel:
    s_cmp_ge_u32 s2, 256
    s_cbranch_scc1 L_end
    s_load_dwordx16 s[8:23], s[0:1], 0
    s_load_dwordx16 s[24:39], s[0:1], 64
    s_load_dwordx2 s[40:41], s[0:1], 128
    v_lshrrev_b32 v32, 6, v0
    s_getpc_b64 s[6:7]
L_pc:
    v_lshlrev_b32 v33, 7, v0
    v_min_u32 v33, L_last-L_pc, v33
    global_load_dword v47, v33, s[6:7]
    v_readfirstlane_b32 s4, v32
    s_and_b32 s3, s2, 7
    s_lshl_b32 s3, s3, 5
    s_lshr_b32 s5, s2, 3
    s_add_u32 s3, s3, s5
    v_and_b32 v16, 63, v0
    s_mov_b32 s42, 67108864
    s_mov_b32 s43, 0x00020000
    s_lshl_b32 s70, s3, 2
    s_brev_b32 s5, s4
    s_lshr_b32 s5, s5, 30
    s_add_u32 s5, s5, s70
    s_lshl_b32 s5, s5, 7
    v_lshl_add_u32 v48, v16, 1, s5
    v_and_b32 v33, 3, v0
    s_cmp_lt_u32 s4, 4
    s_cbranch_scc1 L_cw1
    s_lshl2_add_u32 s5, s3, s4
    s_sub_u32 s5, s5, 4
    s_lshl_b32 s5, s5, 11
    v_and_b32 v35, 31, v0
    v_lshlrev_b32 v35, 4, v35
    v_bfe_u32 v40, v0, 5, 1
    v_lshl_add_u32 v1, v40, 10, v35
    v_add_u32 v1, s5, v1
    v_lshlrev_b32 v15, 4, v16
    v_lshrrev_b32 v34, 4, v16
    v_mov_b32 v3, 0xffff0000
    s_waitcnt lgkmcnt(0)
    global_load_dwordx4 v[64:67], v1, s[8:9] nt
    global_load_dwordx4 v[68:71], v1, s[8:9] offset:512 nt
    s_load_dword s48, s[40:41], 0
    s_branch L_hw2
L_cw1:
    v_mov_b32 v40, 0
    v_mov_b32 v41, 0
    s_mul_i32 s7, s4, 1600
    s_add_u32 s7, s7, 76416
    v_lshl_add_u32 v36, v16, 3, s7
    s_min_u32 s7, s4, 2
    s_lshl_b32 s7, s7, 9
    s_add_u32 s7, s7, 76416
    v_lshl_add_u32 v37, v16, 3, s7
    s_sub_u32 s6, s4, 16
    v_and_b32 v32, 0x38, v16
    ds_write_b64 v36, v[40:41]
    ds_write_b64 v36, v[40:41] offset:12032
    ds_write_b64 v37, v[40:41] offset:6400
    ds_write_b64 v37, v[40:41] offset:18432
    v_lshl_add_u32 v32, v32, 1, s6
    v_lshl_add_u32 v32, v33, 2, v32
    s_mov_b32 s6, 0x3807c0
    s_mov_b32 s7, 0xfe01ff0
    v_mov_b32 v38, 0
    s_mov_b32 exec_lo, 0xf0f0f000
    s_mov_b32 exec_hi, 0xf0
    v_lshrrev_b64 v[38:39], v32, s[6:7]
    s_mov_b64 exec, -1
    v_bfe_u32 v39, v38, 2, 2
    v_and_b32 v38, 3, v38
    v_mul_u32_u24 v38, 0x8001, v38
    v_mul_u32_u24 v39, 0x8001, v39
    v_and_b32 v38, 0x10001, v38
    v_and_b32 v39, 0x10001, v39
    v_mul_u32_u24 v38, 0x3c00, v38
    v_mul_u32_u24 v39, 0x3c00, v39
    v_mov_b32 v42, 0
    ds_write_b64 v36, v[38:39] offset:1024
    ds_write_b64 v36, v[38:39] offset:13056
    v_mov_b32 v43, 0
    v_mov_b32 v44, 0
    v_mov_b32 v45, 0
    s_waitcnt lgkmcnt(0)
    s_load_dword s48, s[40:41], 0
    s_load_dword s59, s[22:23], s70
    s_load_dword s66, s[24:25], s70
    s_barrier
    global_load_short_d16_hi v40, v48, s[10:11] nt
    global_load_short_d16_hi v41, v48, s[12:13] nt
    global_load_short_d16_hi v42, v48, s[14:15] nt
    global_load_short_d16_hi v43, v48, s[16:17] nt
    global_load_short_d16_hi v44, v48, s[18:19] nt
    global_load_short_d16_hi v45, v48, s[20:21] nt
    s_branch L_cw2
L_hw2:
    s_barrier
    s_mov_b32 s55, 0x00020000
    s_and_b32 s7, s4, 3
    s_lshr_b32 s70, s3, 5
    s_add_u32 s71, s3, 24
    s_and_b32 s71, s71, 31
    s_mul_i32 s72, s70, 5
    s_max_u32 s5, s70, 5
    s_add_u32 s72, s72, s5
    s_lshl2_add_u32 s63, s72, s71
    s_sub_u32 s63, s63, 20
    s_cmp_ge_u32 s70, 5
    s_cselect_b32 s73, 24, 20
    s_cmp_ge_u32 s71, 24
    s_cselect_b32 s61, 2, 0
    s_cmp_lt_u32 s71, s73
    s_cselect_b32 s61, 1, s61
    s_cselect_b32 s54, 1409024, 0
    s_and_b32 s5, s71, 3
    s_lshl2_add_u32 s5, s5, s7
    s_mul_i32 s5, s5, 88064
    s_and_b32 s6, s63, 0xfffc
    s_lshl4_add_u32 s5, s6, s5
    v_lshrrev_b32 v36, 2, v16
    v_mul_u32_u24 v36, 2752, v36
    s_mul_i32 s74, s7, 2048
    v_lshl_add_u32 v36, v33, 4, v36
    s_add_u32 s74, s74, 109184
    v_add_u32 v24, s5, v36
    s_cmp_eq_u32 s4, 7
    s_cselect_b32 s5, 1, s61
    s_cmp_eq_u32 s5, 1
    s_cselect_b32 s58, 0, 0x40000000
    v_add_u32 v25, s58, v15
    v_mov_b32 v30, 0
    global_load_dwordx4 v[72:75], v35, s[28:29]
    global_load_dwordx4 v[76:79], v35, s[28:29] offset:512
    s_sub_u32 s49, 255, s3
    v_mov_b32 v13, 0xfff8fff8
    s_mov_b32 s68, 0
    v_mov_b32 v14, 83712
    s_mov_b32 s75, 0
    v_bfe_u32 v36, v0, 2, 2
    s_mov_b32 s69, 0
    v_mul_u32_u24 v36, 1088, v36
    v_and_b32 v37, 0xf0, v0
    v_lshl_add_u32 v36, v37, 1, v36
    v_lshl_add_u32 v36, v33, 3, v36
    v_add_u32 v18, 100480, v36
    s_and_b32 s5, s4, 1
    s_mul_i32 s71, s5, 12032
    s_add_u32 s71, s71, 76416
    v_and_b32 v32, 15, v16
    s_mul_i32 s7, s5, 31552
    v_lshl_add_u32 v37, v34, 4, s7
    s_and_b32 s6, s4, 2
    v_mov_b32 v38, 544
    s_lshl_b32 s6, s6, 7
    v_mad_u32_u24 v20, v32, v38, v37
    s_add_u32 s14, s7, s6
    v_mul_u32_u24 v23, 1598, v33
    s_lshl_b32 s6, s5, 4
    v_lshrrev_b32 v39, 2, v16
    s_sub_u32 s17, 16, s6
    v_lshl_add_u32 v23, v39, 1, v23
    v_add_u32 v23, s71, v23
    v_add_u32 v1, s6, v14
    s_add_u32 s6, s71, 6520
    v_lshl_add_u32 v36, v34, 7, s6
    v_lshl_add_u32 v21, v32, 2, v36
    v_add_u32 v22, 2, v21
    s_mov_b32 exec_lo, 0
    v_lshl_add_u32 v21, v32, 1, v36
    v_add_u32 v21, 196, v21
    v_add_u32 v22, 32, v21
    s_mov_b32 exec_lo, -1
    v_mov_b32 v27, v34
    v_mov_b32 v31, 0xffffffc0
    v_lshlrev_b32 v29, 8, v16
    s_lshl_b32 s6, s4, 1
    s_sub_u32 s6, 15, s6
    v_sub_u32 v40, s6, v40
    v_mul_u32_u24 v36, 1088, v40
    s_mov_b32 s7, 100480
    v_add3_u32 v17, v36, v35, s7
    s_lshl_b32 s6, s49, 8
    v_lshl_add_u32 v59, v40, 5, s6
    s_mov_b32 s6, 134016
    v_lshl_add_u32 v63, v40, 3, s6
    v_and_b32 v52, 0x38, v16
    v_add_u32 v53, s6, v52
    v_and_b32 v36, 7, v0
    v_lshl_add_u32 v54, v36, 3, s6
    v_mul_u32_u24 v55, 4096, v36
    v_bfe_u32 v2, v0, 6, 2
    v_lshlrev_b32 v2, 18, v2
    v_lshl_add_u32 v2, v16, 4, v2
    s_lshl_b32 s57, s3, 10
    s_add_u32 s57, s57, 2097152
    s_add_u32 s56, s57, 0x100000
    s_mov_b32 s16, 0x3b003b00
    v_mov_b32 v60, 0
    v_mov_b32 v61, 0
    v_mov_b32 v62, 0
    v_mov_b32 v39, 1
    s_mov_b32 s52, s30
    s_mov_b32 s53, s31
    s_add_u32 m0, s74, 0
    s_nop 0
    buffer_load_dwordx4 v24, s[52:55], 0 offen nt lds
    s_mov_b32 s5, 44032
    s_add_u32 m0, s74, 1024
    s_nop 0
    buffer_load_dwordx4 v24, s[52:55], s5 offen nt lds
    s_mov_b32 s52, s32
    s_mov_b32 s53, s33
    s_add_u32 m0, s74, 8192
    s_nop 0
    buffer_load_dwordx4 v24, s[52:55], 0 offen nt lds
    s_mov_b32 s5, 44032
    s_add_u32 m0, s74, 9216
    s_nop 0
    buffer_load_dwordx4 v24, s[52:55], s5 offen nt lds
    s_waitcnt lgkmcnt(0)
    s_add_u32 s48, s48, 1
    s_and_b32 s44, s48, 0x00070007
    s_lshr_b32 s45, s48, 3
    s_and_b32 s45, s45, 0x00070007
    s_lshr_b32 s46, s48, 6
    s_and_b32 s46, s46, 0x00070007
    s_lshr_b32 s47, s48, 9
    s_and_b32 s47, s47, 0x00070007
    s_and_b32 s5, s48, 15
    v_or_b32 v59, s5, v59
    s_bfe_u32 s10, s48, 393216
    s_bfe_u32 s11, s48, 393222
    s_bfe_u32 s12, s48, 393228
    s_bfe_u32 s13, s48, 393234
    s_setprio 3
    s_waitcnt vmcnt(7)
    v_dot2c_f32_bf16 v60, s16, v64
    v_dot2c_f32_bf16 v61, v64, v64
    v_dot2c_f32_bf16 v60, s16, v65
    v_dot2c_f32_bf16 v61, v65, v65
    v_dot2c_f32_bf16 v60, s16, v66
    v_dot2c_f32_bf16 v61, v66, v66
    v_dot2c_f32_bf16 v60, s16, v67
    v_dot2c_f32_bf16 v61, v67, v67
    v_lshlrev_b32 v80, 16, v64
    v_and_b32 v81, v3, v64
    v_lshlrev_b32 v82, 16, v65
    s_waitcnt vmcnt(6)
    v_dot2c_f32_bf16 v60, s16, v68
    v_dot2c_f32_bf16 v61, v68, v68
    v_dot2c_f32_bf16 v60, s16, v69
    v_dot2c_f32_bf16 v61, v69, v69
    v_dot2c_f32_bf16 v60, s16, v70
    v_dot2c_f32_bf16 v61, v70, v70
    v_dot2c_f32_bf16 v60, s16, v71
    v_dot2c_f32_bf16 v61, v71, v71
    v_and_b32 v83, v3, v65
    v_lshlrev_b32 v84, 16, v66
    v_and_b32 v85, v3, v66
    v_permlane16_swap_b32 v60, v61
    v_add_f32 v60, v60, v61
    v_lshlrev_b32 v86, 16, v67
    v_and_b32 v87, v3, v67
    v_add_f32_dpp v60, v60, v60 quad_perm:[1,0,3,2] row_mask:0xf bank_mask:0xf
    v_lshlrev_b32 v88, 16, v68
    v_and_b32 v89, v3, v68
    v_add_f32_dpp v60, v60, v60 quad_perm:[2,3,0,1] row_mask:0xf bank_mask:0xf
    v_lshlrev_b32 v90, 16, v69
    v_and_b32 v91, v3, v69
    v_add_f32_dpp v60, v60, v60 row_half_mirror row_mask:0xf bank_mask:0xf
    v_lshlrev_b32 v92, 16, v70
    v_and_b32 v93, v3, v70
    v_add_f32_dpp v61, v60, v60 row_mirror row_mask:0xf bank_mask:0xf
    v_add_f32_dpp v60, v60, v60 row_mirror row_mask:0xf bank_mask:0xf
    v_lshlrev_b32 v94, 16, v71
    v_and_b32 v95, v3, v71
    v_permlane16_swap_b32 v60, v61
    v_mul_f32 v33, 0x3b000000, v61
    v_cvt_pk_bf16_f32 v32, 0, v60
    v_fma_f32 v33, -v60, v60, v33
    v_pk_add_f32 v[80:81], v[80:81], v[32:33] op_sel_hi:[1,0] neg_lo:[0,1] neg_hi:[0,1]
    v_max_f32 v33, 0, v33
    v_pk_add_f32 v[82:83], v[82:83], v[32:33] op_sel_hi:[1,0] neg_lo:[0,1] neg_hi:[0,1]
    v_cvt_pk_bf16_f32 v33, 0, v33
    v_pk_add_f32 v[84:85], v[84:85], v[32:33] op_sel_hi:[1,0] neg_lo:[0,1] neg_hi:[0,1]
    v_add_f32 v33, 0x3727c5ac, v33
    v_pk_add_f32 v[86:87], v[86:87], v[32:33] op_sel_hi:[1,0] neg_lo:[0,1] neg_hi:[0,1]
    v_cvt_pk_bf16_f32 v33, 0, v33
    v_pk_add_f32 v[88:89], v[88:89], v[32:33] op_sel_hi:[1,0] neg_lo:[0,1] neg_hi:[0,1]
    v_sqrt_f32 v35, v33
    v_pk_add_f32 v[90:91], v[90:91], v[32:33] op_sel_hi:[1,0] neg_lo:[0,1] neg_hi:[0,1]
    v_pk_add_f32 v[92:93], v[92:93], v[32:33] op_sel_hi:[1,0] neg_lo:[0,1] neg_hi:[0,1]
    v_cvt_pk_bf16_f32 v35, 0, v35
    v_pk_add_f32 v[94:95], v[94:95], v[32:33] op_sel_hi:[1,0] neg_lo:[0,1] neg_hi:[0,1]
    v_rcp_f32 v36, v35
    v_cvt_pk_bf16_f32 v80, 0, v80
    v_cvt_pk_bf16_f32 v81, 0, v81
    v_cvt_pk_bf16_f32 v82, 0, v82
    v_cvt_pk_bf16_f32 v83, 0, v83
    v_cvt_pk_bf16_f32 v84, 0, v84
    v_cvt_pk_bf16_f32 v85, 0, v85
    v_cvt_pk_bf16_f32 v86, 0, v86
    v_cvt_pk_bf16_f32 v87, 0, v87
    v_cvt_pk_bf16_f32 v88, 0, v88
    v_cvt_pk_bf16_f32 v89, 0, v89
    v_cvt_pk_bf16_f32 v90, 0, v90
    v_cvt_pk_bf16_f32 v91, 0, v91
    v_cvt_pk_bf16_f32 v92, 0, v92
    v_cvt_pk_bf16_f32 v93, 0, v93
    v_cvt_pk_bf16_f32 v94, 0, v94
    v_cvt_pk_bf16_f32 v95, 0, v95
    v_pk_mul_f32 v[80:81], v[80:81], v[36:37] op_sel_hi:[1,0]
    v_pk_mul_f32 v[82:83], v[82:83], v[36:37] op_sel_hi:[1,0]
    v_pk_mul_f32 v[84:85], v[84:85], v[36:37] op_sel_hi:[1,0]
    v_pk_mul_f32 v[86:87], v[86:87], v[36:37] op_sel_hi:[1,0]
    v_cvt_pk_bf16_f32 v96, v80, v81
    v_cvt_pk_bf16_f32 v97, v82, v83
    v_cvt_pk_bf16_f32 v98, v84, v85
    v_cvt_pk_bf16_f32 v99, v86, v87
    v_lshlrev_b32 v104, 16, v96
    v_lshlrev_b32 v105, 16, v97
    v_lshlrev_b32 v106, 16, v98
    v_lshlrev_b32 v107, 16, v99
    v_cvt_pkrtz_f16_f32 v104, v104, v96
    v_cvt_pkrtz_f16_f32 v105, v105, v97
    v_cvt_pkrtz_f16_f32 v106, v106, v98
    v_cvt_pkrtz_f16_f32 v107, v107, v99
    v_pk_mul_f32 v[88:89], v[88:89], v[36:37] op_sel_hi:[1,0]
    v_pk_mul_f32 v[90:91], v[90:91], v[36:37] op_sel_hi:[1,0]
    v_pk_mul_f32 v[92:93], v[92:93], v[36:37] op_sel_hi:[1,0]
    v_pk_mul_f32 v[94:95], v[94:95], v[36:37] op_sel_hi:[1,0]
    v_cvt_pk_bf16_f32 v100, v88, v89
    v_cvt_pk_bf16_f32 v101, v90, v91
    v_cvt_pk_bf16_f32 v102, v92, v93
    v_cvt_pk_bf16_f32 v103, v94, v95
    v_lshlrev_b32 v108, 16, v100
    v_lshlrev_b32 v109, 16, v101
    v_lshlrev_b32 v110, 16, v102
    v_lshlrev_b32 v111, 16, v103
    v_cvt_pkrtz_f16_f32 v108, v108, v100
    v_cvt_pkrtz_f16_f32 v109, v109, v101
    v_cvt_pkrtz_f16_f32 v110, v110, v102
    v_cvt_pkrtz_f16_f32 v111, v111, v103
    ds_write_b128 v17, v[104:107] offset:0
    ds_write_b128 v17, v[108:111] offset:512
    s_mov_b64 exec, 1
    ds_add_u32 v14, v39 offset:40
    s_mov_b64 exec, -1
    ds_read_b32 v42, v14 offset:40
    ds_read_b64_tr_b16 v[112:113], v18 offset:0
    ds_read_b64_tr_b16 v[114:115], v18 offset:4352
    ds_read_b64_tr_b16 v[116:117], v18 offset:512
    ds_read_b64_tr_b16 v[118:119], v18 offset:4864
    s_waitcnt vmcnt(4)
    v_dot2c_f32_bf16 v62, v96, v72
    v_dot2c_f32_bf16 v62, v97, v73
    v_dot2c_f32_bf16 v62, v98, v74
    v_dot2c_f32_bf16 v62, v99, v75
    v_dot2c_f32_bf16 v62, v100, v76
    v_dot2c_f32_bf16 v62, v101, v77
    v_dot2c_f32_bf16 v62, v102, v78
    v_dot2c_f32_bf16 v62, v103, v79
    v_cvt_pk_bf16_f32 v33, v32, v35
    s_nop 1
    v_add_f32_dpp v62, v62, v62 row_shr:1 row_mask:0xf bank_mask:0xf bound_ctrl:0
    s_nop 1
    v_add_f32_dpp v62, v62, v62 row_shr:2 row_mask:0xf bank_mask:0xf bound_ctrl:0
    s_nop 1
    v_add_f32_dpp v62, v62, v62 row_shr:4 row_mask:0xf bank_mask:0xf bound_ctrl:0
    s_waitcnt lgkmcnt(0)
    v_cmp_gt_u32 vcc, 4, v42
    v_and_or_b32 v112, v112, v13, s44
    v_and_or_b32 v113, v113, v13, s45
    v_and_or_b32 v114, v114, v13, s46
    v_and_or_b32 v115, v115, v13, s47
    s_cbranch_vccz L_x1o
L_x1r:
    ds_read_b32 v42, v14 offset:40
    ds_read_b64_tr_b16 v[112:113], v18 offset:0
    ds_read_b64_tr_b16 v[114:115], v18 offset:4352
    ds_read_b64_tr_b16 v[116:117], v18 offset:512
    ds_read_b64_tr_b16 v[118:119], v18 offset:4864
    s_add_u32 s68, s68, 1
    s_cmp_ge_u32 s68, 960000
    s_waitcnt lgkmcnt(4)
    s_cbranch_scc1 L_x1o
    v_cmp_gt_u32 vcc, 4, v42
    s_cbranch_vccnz L_x1r
    s_waitcnt lgkmcnt(0)
    v_and_or_b32 v112, v112, v13, s44
    v_and_or_b32 v113, v113, v13, s45
    v_and_or_b32 v114, v114, v13, s46
    v_and_or_b32 v115, v115, v13, s47
L_x1o:
    buffer_store_dwordx4 v[112:115], v2, s[40:43], s57 offen sc1
    v_and_or_b32 v116, v116, v13, s44
    v_and_or_b32 v117, v117, v13, s45
    v_and_or_b32 v118, v118, v13, s46
    v_and_or_b32 v119, v119, v13, s47
    buffer_store_dwordx4 v[116:119], v2, s[40:43], s56 offen sc1
    v_add_f32_dpp v62, v62, v62 row_shr:8 row_mask:0xf bank_mask:0xf bound_ctrl:0
    s_nop 1
    v_add_f32_dpp v62, v62, v62 row_bcast:15 row_mask:0xa bank_mask:0xf
    v_cvt_pk_bf16_f32 v62, 0, v62
    s_brev_b32 s5, 1
    v_ashrrev_i32 v32, 31, v62
    s_mov_b32 exec_lo, s5
    v_bitop3_b32 v32, v62, v32, s5 bitop3:0x1e
    s_mov_b32 exec_hi, s5
    v_and_or_b32 v32, v32, v3, v59
    ds_write_b64 v63, v[32:33]
    s_mov_b64 exec, 1
    ds_add_u32 v14, v39 offset:44
    s_mov_b64 exec, -1
    s_cmp_lg_u32 s4, 6
    s_cbranch_scc1 L_nokey
    s_lshl4_add_u32 s5, s49, 4096
L_kp:
    ds_read_b32 v42, v14 offset:44
    ds_read_b64 v[32:33], v53
    ds_read_b32 v34, v54
    s_add_u32 s69, s69, 1
    s_cmp_ge_u32 s69, 960000
    s_waitcnt lgkmcnt(0)
    s_cbranch_scc1 L_kpx
    v_cmp_gt_u32 vcc, 8, v42
    s_cbranch_vccnz L_kp
L_kpx:
    v_cmp_gt_u32 vcc, v34, v32
    s_nop 1
    v_lshrrev_b64 v[40:41], v52, vcc
    v_and_b32 v40, 0xff, v40
    v_bcnt_u32_b32 v40, v40, 0
    v_cmpx_gt_u32 vcc, 2, v40
    v_lshl_or_b32 v32, v40, 4, v32
    v_lshl_add_u32 v40, v40, 3, v55
    buffer_store_dwordx2 v[32:33], v40, s[40:43], s5 offen sc1
    s_mov_b64 exec, -1
    s_mov_b32 s69, 0
L_nokey:
    s_setprio 2
    s_and_b32 s5, s4, 1
    s_and_b32 s6, s63, 3
    s_lshl1_add_u32 s6, s6, s5
    s_and_b32 s7, s63, 0xfffc
    s_lshl_b32 s7, s7, 6
    s_add_u32 s6, s6, s7
    s_lshl_b32 s6, s6, 7
    v_lshrrev_b32 v36, 3, v16
    v_lshl_add_u32 v36, v36, 10, s6
    v_and_b32 v37, 7, v16
    v_lshl_add_u32 v164, v37, 4, v36
    s_mul_i32 s62, s5, 4224
    s_add_u32 s62, s62, 125568
    s_cmp_ge_u32 s4, 6
    s_cbranch_scc1 L_d213
    buffer_load_dword v30, v3, s[40:43], 0 offen
    buffer_load_dword v30, v3, s[40:43], 0 offen
    buffer_load_dword v30, v3, s[40:43], 0 offen
    buffer_load_dword v30, v3, s[40:43], 0 offen
    s_branch L_dd14
L_d213:
    s_mov_b32 s52, s34
    s_mov_b32 s53, s35
    s_mov_b32 s5, 0
    s_add_u32 m0, s62, 0
    s_nop 0
    buffer_load_dwordx4 v164, s[52:55], s5 offen nt lds
    s_mov_b32 s5, 8192
    s_add_u32 m0, s62, 1056
    s_nop 0
    buffer_load_dwordx4 v164, s[52:55], s5 offen nt lds
    s_mov_b32 s5, 16384
    s_add_u32 m0, s62, 2112
    s_nop 0
    buffer_load_dwordx4 v164, s[52:55], s5 offen nt lds
    s_mov_b32 s5, 24576
    s_add_u32 m0, s62, 3168
    s_nop 0
    buffer_load_dwordx4 v164, s[52:55], s5 offen nt lds
L_dd14:
    v_and_b32 v36, 31, v16
    v_lshrrev_b32 v37, 5, v16
    s_lshr_b32 s5, s3, 5
    s_lshl_b32 s6, s5, 7
    v_lshl_add_u32 v161, v36, 2, s6
    s_and_b32 s6, s3, 31
    s_and_b32 s7, s4, 3
    s_lshl2_add_u32 s6, s6, s7
    s_lshl_b32 s57, s5, 18
    s_lshl_b32 s5, s6, 11
    s_add_u32 s57, s57, s5
    s_add_u32 s57, s57, 2097152
    s_and_b32 s5, s6, 0x7e
    s_add_u32 s5, s5, s6
    s_sub_u32 s50, 253, s5
    s_and_b32 s7, s5, 7
    s_lshl_b32 s5, s5, 13
    s_add_u32 s5, s5, 4096
    v_lshl_add_u32 v162, v37, 14, v161
    v_add_u32 v162, s5, v162
    v_lshrrev_b32 v40, 2, v36
    v_lshlrev_b32 v40, 7, v40
    v_lshl_add_u32 v40, v37, 4, v40
    v_and_b32 v41, 3, v36
    v_lshl_add_u32 v160, v41, 5, v40
    s_xor_b32 s67, s47, 262144
    v_mov_b32 v165, 0
    v_mov_b32 v166, 0
    s_mov_b32 s21, 0
    s_and_b32 s6, s6, 0x7d
    s_bitcmp1_b32 s6, 0
    s_addc_u32 s6, s6, 0
    s_lshl_b32 s6, s6, 14
    s_and_b32 s5, s3, 0xe0
    s_lshl2_add_u32 s6, s5, s6
    v_lshrrev_b32 v40, 3, v16
    v_lshl_add_u32 v40, v40, 10, s6
    v_and_b32 v41, 7, v16
    v_lshl_add_u32 v56, v41, 4, v40
    s_lshl_b32 s7, s7, 10
    s_add_u32 s7, s7, 134080
    v_lshl_add_u32 v40, v37, 11, s7
    v_and_b32 v41, 31, v16
    v_lshl_add_u32 v57, v41, 2, v40
    s_and_b32 s51, s63, 0xfffc
    s_lshl_b32 s51, s51, 9
    s_add_u32 s51, s51, 65536
    v_bfe_u32 v32, v16, 1, 3
    v_and_b32 v34, 1, v16
    v_lshl_add_u32 v36, v27, 1, v34
    v_lshl_add_u32 v36, v36, 4, v32
    v_lshlrev_b32 v167, 4, v36
    s_and_b32 s5, s4, 1
    s_lshl_b32 s5, s5, 7
    s_add_u32 s5, s5, s51
    buffer_load_dword v30, v167, s[40:43], s5 offen
    s_lshr_b32 s73, s3, 5
    s_mul_i32 s73, s73, 4096
    s_add_u32 s73, s73, 4096
    s_cmp_ge_u32 s4, 6
    s_cbranch_scc1 L_w67
    s_mov_b32 s71, 0
L_gf:
    ds_read_b32 v42, v1 offset:52
    s_add_u32 s71, s71, 1
    s_cmp_ge_u32 s71, 960000
    s_waitcnt lgkmcnt(0)
    s_cbranch_scc1 L_gfx
    v_cmp_gt_u32 vcc, 2, v42
    s_cbranch_vccnz L_gf
L_gfx:
    ds_read_b128 v[64:67], v20 offset:27456
    ds_read_b128 v[68:71], v20 offset:36160
    ds_read_b128 v[72:75], v20 offset:27520
    ds_read_b128 v[76:79], v20 offset:36224
    ds_read_b128 v[80:83], v20 offset:27584
    ds_read_b128 v[84:87], v20 offset:36288
    ds_read_b128 v[88:91], v20 offset:27648
    ds_read_b128 v[92:95], v20 offset:36352
    ds_read_b128 v[96:99], v20 offset:27712
    ds_read_b128 v[100:103], v20 offset:36416
    ds_read_b128 v[104:107], v20 offset:27776
    ds_read_b128 v[108:111], v20 offset:36480
    ds_read_b128 v[112:115], v20 offset:27840
    ds_read_b128 v[116:119], v20 offset:36544
    ds_read_b128 v[120:123], v20 offset:27904
    ds_read_b128 v[124:127], v20 offset:36608
    s_waitcnt lgkmcnt(14)
    v_mfma_f32_16x16x32_f16 v[40:43], v[64:67], v[68:71], 0
    s_waitcnt lgkmcnt(12)
    v_mfma_f32_16x16x32_f16 v[40:43], v[72:75], v[76:79], v[40:43]
    s_waitcnt lgkmcnt(10)
    v_mfma_f32_16x16x32_f16 v[40:43], v[80:83], v[84:87], v[40:43]
    s_waitcnt lgkmcnt(8)
    v_mfma_f32_16x16x32_f16 v[40:43], v[88:91], v[92:95], v[40:43]
    s_waitcnt lgkmcnt(6)
    v_mfma_f32_16x16x32_f16 v[40:43], v[96:99], v[100:103], v[40:43]
    s_waitcnt lgkmcnt(4)
    v_mfma_f32_16x16x32_f16 v[40:43], v[104:107], v[108:111], v[40:43]
    s_waitcnt lgkmcnt(2)
    v_mfma_f32_16x16x32_f16 v[40:43], v[112:115], v[116:119], v[40:43]
    s_waitcnt lgkmcnt(0)
    v_mfma_f32_16x16x32_f16 v[40:43], v[120:123], v[124:127], v[40:43]
    s_nop 7
    v_cvt_pk_f16_f32 v45, v42, v43
    v_cvt_pk_f16_f32 v44, v40, v41
    v_readlane_b32 s6, v45, 31
    s_nop 1
    v_mov_b32 v47, s6
    ds_write_b16 v21, v45 offset:64
    ds_write_b16_d16_hi v22, v45 offset:64
    ds_write_b16 v21, v44
    ds_write_b16_d16_hi v22, v44
    s_mov_b64 exec, 0xff
    ds_write_b16 v23, v47 offset:1382
    s_mov_b64 exec, 1
    ds_add_u32 v1, v39 offset:60
    s_mov_b64 exec, -1
    s_setprio 0
    s_waitcnt vmcnt(7)
    s_mov_b64 exec, 1
    ds_add_u32 v14, v39 offset:84
    s_mov_b64 exec, -1
    s_branch L_lut
L_w67:
    s_setprio 0
L_lut:
    v_and_b32 v36, 255, v0
    s_mov_b32 s5, 0x80000
    s_mov_b32 s6, 0x100010
    v_mov_b32 v37, s5
    v_mad_u32_u24 v64, v36, s6, v37
    v_lshlrev_b32 v36, 2, v36
    s_mov_b32 s5, 0xbfb8aa3b
    v_add_u32 v65, 0x10001000, v64
    v_add_u32 v66, 0x20002000, v64
    v_add_u32 v67, 0x30003000, v64
    v_add_u32 v68, 0x40004000, v64
    v_fma_mix_f32 v72, v64, s5, 0 op_sel:[0,0,0] op_sel_hi:[1,0,0]
    v_fma_mix_f32 v73, v64, s5, 0 op_sel:[1,0,0] op_sel_hi:[1,0,0]
    v_fma_mix_f32 v74, v65, s5, 0 op_sel:[0,0,0] op_sel_hi:[1,0,0]
    v_fma_mix_f32 v75, v65, s5, 0 op_sel:[1,0,0] op_sel_hi:[1,0,0]
    v_fma_mix_f32 v76, v66, s5, 0 op_sel:[0,0,0] op_sel_hi:[1,0,0]
    v_fma_mix_f32 v77, v66, s5, 0 op_sel:[1,0,0] op_sel_hi:[1,0,0]
    v_fma_mix_f32 v78, v67, s5, 0 op_sel:[0,0,0] op_sel_hi:[1,0,0]
    v_fma_mix_f32 v79, v67, s5, 0 op_sel:[1,0,0] op_sel_hi:[1,0,0]
    v_fma_mix_f32 v80, v68, s5, 0 op_sel:[0,0,0] op_sel_hi:[1,0,0]
    v_fma_mix_f32 v81, v68, s5, 0 op_sel:[1,0,0] op_sel_hi:[1,0,0]
    v_exp_f32 v72, v72
    v_exp_f32 v73, v73
    v_exp_f32 v74, v74
    v_exp_f32 v75, v75
    v_exp_f32 v76, v76
    v_exp_f32 v77, v77
    v_exp_f32 v78, v78
    v_exp_f32 v79, v79
    v_exp_f32 v80, v80
    v_exp_f32 v81, v81
    v_add_f32 v84, 1.0, v72
    v_add_f32 v85, 1.0, v73
    v_add_f32 v86, 1.0, v74
    v_add_f32 v87, 1.0, v75
    v_add_f32 v88, 1.0, v76
    v_add_f32 v89, 1.0, v77
    v_add_f32 v90, 1.0, v78
    v_add_f32 v91, 1.0, v79
    v_add_f32 v92, 1.0, v80
    v_add_f32 v93, 1.0, v81
    v_rcp_f32 v84, v84
    v_rcp_f32 v85, v85
    v_rcp_f32 v86, v86
    v_rcp_f32 v87, v87
    v_rcp_f32 v88, v88
    v_rcp_f32 v89, v89
    v_rcp_f32 v90, v90
    v_rcp_f32 v91, v91
    v_rcp_f32 v92, v92
    v_rcp_f32 v93, v93
    v_fma_mix_f32 v84, v64, v84, 0 op_sel:[0,0,0] op_sel_hi:[1,0,0]
    v_fma_mix_f32 v85, v64, v85, 0 op_sel:[1,0,0] op_sel_hi:[1,0,0]
    v_fma_mix_f32 v86, v65, v86, 0 op_sel:[0,0,0] op_sel_hi:[1,0,0]
    v_fma_mix_f32 v87, v65, v87, 0 op_sel:[1,0,0] op_sel_hi:[1,0,0]
    v_fma_mix_f32 v88, v66, v88, 0 op_sel:[0,0,0] op_sel_hi:[1,0,0]
    v_fma_mix_f32 v89, v66, v89, 0 op_sel:[1,0,0] op_sel_hi:[1,0,0]
    v_fma_mix_f32 v90, v67, v90, 0 op_sel:[0,0,0] op_sel_hi:[1,0,0]
    v_fma_mix_f32 v91, v67, v91, 0 op_sel:[1,0,0] op_sel_hi:[1,0,0]
    v_fma_mix_f32 v92, v68, v92, 0 op_sel:[0,0,0] op_sel_hi:[1,0,0]
    v_fma_mix_f32 v93, v68, v93, 0 op_sel:[1,0,0] op_sel_hi:[1,0,0]
    v_mul_f32 v72, -v84, v72
    v_mul_f32 v73, -v85, v73
    v_mul_f32 v74, -v86, v74
    v_mul_f32 v75, -v87, v75
    v_mul_f32 v76, -v88, v76
    v_mul_f32 v77, -v89, v77
    v_mul_f32 v78, -v90, v78
    v_mul_f32 v79, -v91, v79
    v_mul_f32 v80, -v92, v80
    v_mul_f32 v81, -v93, v81
    v_cvt_pk_bf16_f32 v84, 0, v84
    v_cvt_pk_bf16_f32 v85, 0, v85
    v_cvt_pk_bf16_f32 v86, 0, v86
    v_cvt_pk_bf16_f32 v87, 0, v87
    v_cvt_pk_bf16_f32 v88, 0, v88
    v_cvt_pk_bf16_f32 v89, 0, v89
    v_cvt_pk_bf16_f32 v90, 0, v90
    v_cvt_pk_bf16_f32 v91, 0, v91
    v_cvt_pk_bf16_f32 v92, 0, v92
    v_cvt_pk_bf16_f32 v93, 0, v93
    v_cvt_pk_f16_f32 v84, v84, v85
    ds_write_b32 v36, v84 offset:0
    v_cvt_pk_f16_f32 v86, v86, v87
    ds_write_b32 v36, v86 offset:1024
    v_cvt_pk_f16_f32 v88, v88, v89
    ds_write_b32 v36, v88 offset:2048
    v_cvt_pk_f16_f32 v90, v90, v91
    ds_write_b32 v36, v90 offset:3072
    v_cvt_pk_f16_f32 v92, v92, v93
    ds_write_b32 v36, v92 offset:4096
    v_cvt_pk_bf16_f32 v72, 0, v72
    v_cvt_pk_bf16_f32 v73, 0, v73
    v_cvt_pk_bf16_f32 v74, 0, v74
    v_cvt_pk_bf16_f32 v75, 0, v75
    v_cvt_pk_bf16_f32 v76, 0, v76
    v_cvt_pk_bf16_f32 v77, 0, v77
    v_cvt_pk_bf16_f32 v78, 0, v78
    v_cvt_pk_bf16_f32 v79, 0, v79
    v_cvt_pk_bf16_f32 v80, 0, v80
    v_cvt_pk_bf16_f32 v81, 0, v81
    v_cvt_pk_f16_f32 v72, v72, v73
    ds_write_b32 v36, v72 offset:8192
    v_cvt_pk_f16_f32 v74, v74, v75
    ds_write_b32 v36, v74 offset:9216
    v_cvt_pk_f16_f32 v76, v76, v77
    ds_write_b32 v36, v76 offset:10240
    v_cvt_pk_f16_f32 v78, v78, v79
    ds_write_b32 v36, v78 offset:11264
    v_cvt_pk_f16_f32 v80, v80, v81
    ds_write_b32 v36, v80 offset:12288
    s_cmp_ge_u32 s4, 6
    s_cbranch_scc1 L_w67b
    buffer_load_dword v44, v161, s[40:43], 0 offen offset:2048 sc1
    s_mov_b64 exec, 1
    ds_add_u32 v14, v39 offset:28
    s_mov_b64 exec, -1
    s_getreg_b32 s6, hwreg(HW_REG_XCC_ID, 0, 4)
    s_lshl_b32 s6, s6, 28
    s_xor_b32 s6, s48, s6
    s_and_b32 s5, s4, 1
    s_mul_i32 s7, s5, 12032
    s_add_u32 s7, s7, 84352
    v_add_u32 v40, s7, v15
    s_lshl_b32 s7, s5, 12
    s_add_u32 s7, s7, 100480
    v_add_u32 v41, s7, v15
    s_add_u32 s70, s7, 4094
    v_lshl_add_u32 v46, s5, 2, v14
    v_mov_b32 v47, 0x3c00
    s_mov_b32 s71, 0
L_gx:
    s_waitcnt vmcnt(0)
    v_xor_b32 v44, s6, v44
    v_lshlrev_b32 v45, 4, v44
    v_cmp_ne_u32 vcc, 0, v45
    s_cbranch_vccnz L_gxr
L_gxo:
    v_cmp_ne_u32 vcc, 0, v44
    s_cmp_eq_u64 vcc, 0
    s_cselect_b32 s5, 1, 2
    v_mov_b32 v45, s5
    ds_write_b32 v14, v45 offset:80
    s_setprio 3
    s_mov_b32 s71, 0
L_gw:
    ds_read_b64 v[42:43], v14 offset:24
    s_add_u32 s71, s71, 1
    s_cmp_ge_u32 s71, 960000
    s_waitcnt lgkmcnt(0)
    s_cbranch_scc1 L_gwx
    v_min_u32 v42, v42, v43
    v_cmp_gt_u32 vcc, 4, v42
    s_cbranch_vccnz L_gw
L_gwx:
L_gp:
    ds_read_b128 v[64:67], v40 offset:0
    ds_read_b128 v[68:71], v40 offset:1024
    ds_read_b128 v[72:75], v40 offset:2048
    ds_read_b128 v[76:79], v40 offset:3072
    s_waitcnt lgkmcnt(3)
    v_bfe_u32 v80, v64, 2, 14
    ds_read_u16 v80, v80
    v_lshrrev_b32 v81, 18, v64
    ds_read_u16 v81, v81
    v_bfe_u32 v82, v65, 2, 14
    ds_read_u16 v82, v82
    v_lshrrev_b32 v83, 18, v65
    ds_read_u16 v83, v83
    v_bfe_u32 v84, v66, 2, 14
    ds_read_u16 v84, v84
    v_lshrrev_b32 v85, 18, v66
    ds_read_u16 v85, v85
    v_bfe_u32 v86, v67, 2, 14
    ds_read_u16 v86, v86
    v_lshrrev_b32 v87, 18, v67
    ds_read_u16 v87, v87
    s_waitcnt lgkmcnt(10)
    v_bfe_u32 v88, v68, 2, 14
    ds_read_u16 v88, v88
    v_lshrrev_b32 v89, 18, v68
    ds_read_u16 v89, v89
    v_bfe_u32 v90, v69, 2, 14
    ds_read_u16 v90, v90
    v_lshrrev_b32 v91, 18, v69
    ds_read_u16 v91, v91
    v_bfe_u32 v92, v70, 2, 14
    ds_read_u16 v92, v92
    v_lshrrev_b32 v93, 18, v70
    ds_read_u16 v93, v93
    v_bfe_u32 v94, v71, 2, 14
    ds_read_u16 v94, v94
    v_lshrrev_b32 v95, 18, v71
    ds_read_u16 v95, v95
    s_waitcnt lgkmcnt(8)
    v_lshl_or_b32 v64, v86, 16, v87
    v_lshl_or_b32 v65, v84, 16, v85
    v_lshl_or_b32 v66, v82, 16, v83
    v_lshl_or_b32 v67, v80, 16, v81
    ds_write_b128 v41, v[64:67] offset:0
    v_bfe_u32 v96, v72, 2, 14
    ds_read_u16 v96, v96
    v_lshrrev_b32 v97, 18, v72
    ds_read_u16 v97, v97
    v_bfe_u32 v98, v73, 2, 14
    ds_read_u16 v98, v98
    v_lshrrev_b32 v99, 18, v73
    ds_read_u16 v99, v99
    v_bfe_u32 v100, v74, 2, 14
    ds_read_u16 v100, v100
    v_lshrrev_b32 v101, 18, v74
    ds_read_u16 v101, v101
    v_bfe_u32 v102, v75, 2, 14
    ds_read_u16 v102, v102
    v_lshrrev_b32 v103, 18, v75
    ds_read_u16 v103, v103
    s_waitcnt lgkmcnt(9)
    v_lshl_or_b32 v68, v94, 16, v95
    v_lshl_or_b32 v69, v92, 16, v93
    v_lshl_or_b32 v70, v90, 16, v91
    v_lshl_or_b32 v71, v88, 16, v89
    ds_write_b128 v41, v[68:71] offset:1024
    v_bfe_u32 v104, v76, 2, 14
    ds_read_u16 v104, v104
    v_lshrrev_b32 v105, 18, v76
    ds_read_u16 v105, v105
    v_bfe_u32 v106, v77, 2, 14
    ds_read_u16 v106, v106
    v_lshrrev_b32 v107, 18, v77
    ds_read_u16 v107, v107
    v_bfe_u32 v108, v78, 2, 14
    ds_read_u16 v108, v108
    v_lshrrev_b32 v109, 18, v78
    ds_read_u16 v109, v109
    v_bfe_u32 v110, v79, 2, 14
    ds_read_u16 v110, v110
    v_lshrrev_b32 v111, 18, v79
    ds_read_u16 v111, v111
    s_waitcnt lgkmcnt(9)
    v_lshl_or_b32 v72, v102, 16, v103
    v_lshl_or_b32 v73, v100, 16, v101
    v_lshl_or_b32 v74, v98, 16, v99
    v_lshl_or_b32 v75, v96, 16, v97
    ds_write_b128 v41, v[72:75] offset:2048
    s_mov_b32 s71, 0
L_gs:
    ds_read_b96 v[36:38], v14
    s_add_u32 s71, s71, 1
    s_cmp_ge_u32 s71, 960000
    s_waitcnt lgkmcnt(0)
    s_cbranch_scc1 L_gsx
    v_cmp_gt_u32 vcc, 1, v38
    s_cbranch_vccnz L_gs
L_gsx:
    v_lshl_or_b32 v76, v110, 16, v111
    v_lshl_or_b32 v77, v108, 16, v109
    v_lshl_or_b32 v78, v106, 16, v107
    v_lshl_or_b32 v79, v104, 16, v105
    ds_write_b128 v41, v[76:79] offset:3072
    s_mov_b64 exec, 1
    v_bfe_u32 v36, v36, 5, 11
    v_bfe_u32 v37, v37, 5, 11
    v_lshlrev_b32 v36, 1, v36
    v_lshlrev_b32 v37, 1, v37
    v_sub_u32 v36, s70, v36
    v_sub_u32 v37, s70, v37
    ds_write_b16 v36, v47
    ds_write_b16 v37, v47
    ds_write_b32 v46, v45 offset:16
    s_mov_b64 exec, -1
    s_cmp_lg_u32 s61, 1
    s_cbranch_scc1 L_ffn_done
    s_setprio 0
    s_mov_b32 s71, 0
L_fw15:
    ds_read_b32 v42, v14 offset:32
    s_add_u32 s71, s71, 1
    s_cmp_ge_u32 s71, 960000
    s_waitcnt lgkmcnt(0)
    s_cbranch_scc1 L_fw15x
    v_cmp_gt_u32 vcc, 2, v42
    s_cbranch_vccnz L_fw15
L_fw15x:
    s_branch L_role0y
    s_branch L_ffn_done
L_w67b:
    s_mov_b64 exec, 1
    ds_add_u32 v14, v39 offset:28
    s_mov_b64 exec, -1
    s_mov_b32 s71, 0
L_fw16:
    ds_read_b32 v42, v1 offset:60
    s_add_u32 s71, s71, 1
    s_cmp_ge_u32 s71, 960000
    s_waitcnt lgkmcnt(0)
    s_cbranch_scc1 L_fw16x
    v_cmp_gt_u32 vcc, 1, v42
    s_cbranch_vccnz L_fw16
L_fw16x:
    buffer_load_dwordx4 v[224:227], v25, s[40:43], s73 offen offset:0 sc1
    buffer_load_dwordx4 v[228:231], v25, s[40:43], s73 offen offset:1024 sc1
    buffer_load_dwordx4 v[232:235], v25, s[40:43], s73 offen offset:2048 sc1
    buffer_load_dwordx4 v[236:239], v25, s[40:43], s73 offen offset:3072 sc1
    s_setprio 3
    v_bfe_u32 v32, v16, 2, 2
    v_and_b32 v33, 1, v16
    v_bfe_u32 v34, v16, 1, 1
    s_and_b32 s5, s4, 1
    s_and_b32 s6, s63, 3
    s_lshl_b32 s7, s6, 7
    s_lshl_b32 s70, s5, 10
    s_add_u32 s7, s7, s70
    s_add_u32 s7, s7, s51
    v_and_b32 v36, 8, v16
    v_lshl_add_u32 v36, v36, 6, s7
    v_and_b32 v37, 7, v16
    v_lshl_add_u32 v166, v37, 4, v36
    s_lshl_b32 s7, s5, 5
    s_add_u32 s7, s7, 109184
    v_lshl_add_u32 v36, v27, 3, v32
    v_lshl_add_u32 v36, v36, 6, s7
    v_and_b32 v35, 3, v16
    v_lshl_add_u32 v28, v35, 3, v36
    s_lshl_b32 s6, s6, 8
    v_lshl_add_u32 v36, v34, 6, s6
    v_lshl_add_u32 v26, v27, 4, v36
    v_lshrrev_b32 v37, 1, v27
    v_and_b32 v38, 1, v27
    v_lshl_add_u32 v36, v32, 1, v37
    v_lshl_add_u32 v36, v36, 1, v33
    v_lshl_add_u32 v36, v36, 1, v38
    v_lshlrev_b32 v165, 4, v36
    v_mul_u32_u24 v36, 1056, v27
    v_lshl_add_u32 v36, v35, 3, v36
    v_add_u32 v36, s62, v36
    v_lshl_add_u32 v163, v32, 7, v36
    v_add_u32 v37, 6, v32
    v_and_b32 v37, 7, v37
    v_lshl_add_u32 v59, v37, 7, v36
    s_lshl1_add_u32 s5, s63, s5
    s_lshl_b32 s5, s5, 9
    s_add_u32 s21, s5, 1048576
    s_mov_b32 s18, 0x33333333
    s_mov_b32 s19, 0x33333333
    s_mov_b32 s24, 0xaaaaaaaa
    s_mov_b32 s25, 0xaaaaaaaa
    v_mov_b32 v192, 0x3f803f80
    v_mov_b32 v193, 0x3f803f80
    v_mov_b32 v194, 0x3f803f80
    v_mov_b32 v195, 0x3f803f80
    s_and_b32 s5, s48, 15
    v_or_b32 v240, s5, v29
    v_add_u32 v241, 0x4000, v240
    v_add_u32 v242, 0x8000, v240
    v_add_u32 v243, 0xc000, v240
    s_waitcnt vmcnt(11)
    s_mov_b64 exec, 1
    ds_add_u32 v14, v39 offset:84
    s_mov_b64 exec, -1
    s_cmp_lg_u32 s58, 0
    s_cbranch_scc1 L_notop
    s_cmp_lg_u32 s61, 1
    s_cbranch_scc1 L_nofr
    s_mov_b32 s71, 0
L_fd:
    ds_read_b64 v[42:43], v14 offset:80
    ds_read_b64_tr_b16 v[64:65], v28 offset:0
    ds_read_b64_tr_b16 v[66:67], v28 offset:256
    ds_read_b64_tr_b16 v[68:69], v28 offset:2048
    ds_read_b64_tr_b16 v[70:71], v28 offset:2304
    ds_read_b64_tr_b16 v[72:73], v28 offset:4096
    ds_read_b64_tr_b16 v[74:75], v28 offset:4352
    ds_read_b64_tr_b16 v[76:77], v28 offset:6144
    ds_read_b64_tr_b16 v[78:79], v28 offset:6400
    ds_read_b64_tr_b16 v[80:81], v28 offset:8192
    ds_read_b64_tr_b16 v[82:83], v28 offset:8448
    ds_read_b64_tr_b16 v[84:85], v28 offset:10240
    ds_read_b64_tr_b16 v[86:87], v28 offset:10496
    ds_read_b64_tr_b16 v[88:89], v28 offset:12288
    ds_read_b64_tr_b16 v[90:91], v28 offset:12544
    ds_read_b64_tr_b16 v[92:93], v28 offset:14336
    ds_read_b64_tr_b16 v[94:95], v28 offset:14592
    s_add_u32 s71, s71, 1
    s_cmp_ge_u32 s71, 960000
    s_waitcnt lgkmcnt(15)
    s_cbranch_scc1 L_fdx
    v_lshrrev_b32 v43, 2, v43
    v_cmp_eq_u32 vcc, 0, v43
    s_cbranch_vccnz L_fd
L_fdx:
    v_readfirstlane_b32 s20, v42
    s_waitcnt lgkmcnt(14)
    v_mfma_f32_16x16x32_bf16 v[100:103], v[192:195], v[64:67], 0
    s_waitcnt lgkmcnt(12)
    v_mfma_f32_16x16x32_bf16 v[100:103], v[192:195], v[68:71], v[100:103]
    s_waitcnt lgkmcnt(10)
    v_mfma_f32_16x16x32_bf16 v[100:103], v[192:195], v[72:75], v[100:103]
    s_waitcnt lgkmcnt(8)
    v_mfma_f32_16x16x32_bf16 v[100:103], v[192:195], v[76:79], v[100:103]
    s_waitcnt lgkmcnt(6)
    v_mfma_f32_16x16x32_bf16 v[104:107], v[192:195], v[80:83], 0
    s_waitcnt lgkmcnt(4)
    v_mfma_f32_16x16x32_bf16 v[104:107], v[192:195], v[84:87], v[104:107]
    s_waitcnt lgkmcnt(2)
    v_mfma_f32_16x16x32_bf16 v[104:107], v[192:195], v[88:91], v[104:107]
    s_waitcnt lgkmcnt(0)
    v_mfma_f32_16x16x32_bf16 v[104:107], v[192:195], v[92:95], v[104:107]
    s_waitcnt vmcnt(5)
    ds_read_b64_tr_b16 v[128:129], v163 offset:0
    ds_read_b64_tr_b16 v[130:131], v163 offset:512
    ds_read_b64_tr_b16 v[132:133], v163 offset:288
    ds_read_b64_tr_b16 v[134:135], v59 offset:32
    ds_read_b64_tr_b16 v[136:137], v163 offset:576
    ds_read_b64_tr_b16 v[138:139], v163 offset:64
    ds_read_b64_tr_b16 v[140:141], v59 offset:96
    ds_read_b64_tr_b16 v[142:143], v163 offset:352
L_nofr:
    s_setprio 3
    s_waitcnt vmcnt(0)
L_pollk:
    v_xor_b32 v32, v224, v240
    v_xor_b32 v33, v226, v240
    v_bitop3_b32 v32, v32, v228, v241 bitop3:0xf6
    v_bitop3_b32 v33, v33, v230, v241 bitop3:0xf6
    v_bitop3_b32 v32, v32, v232, v242 bitop3:0xf6
    v_bitop3_b32 v33, v33, v234, v242 bitop3:0xf6
    v_bitop3_b32 v32, v32, v236, v243 bitop3:0xf6
    v_bitop3_b32 v33, v33, v238, v243 bitop3:0xf6
    s_movk_i32 s5, 0xf0
    v_or_b32 v32, v32, v33
    v_min_u32 v36, v224, v228
    v_bitop3_b32 v32, v32, v3, s5 bitop3:0x10
    v_max_u32 v34, v224, v228
    v_cmp_ne_u32 vcc, 0, v32
    v_max3_u32 v35, v36, v226, v230
    v_min_u32 v37, v232, v236
    v_max_u32 v40, v232, v236
    s_cbranch_vccnz L_pollk_r
L_pollk_ok:
    v_max3_u32 v41, v37, v234, v238
    v_min_u32 v36, v34, v40
    v_max_u32 v34, v34, v40
    v_max3_u32 v35, v36, v35, v41
    s_mov_b32 vcc_lo, 0xaaaaaaaa
    v_max_u32_dpp v40, v34, v34 row_shr:1 row_mask:0xf bank_mask:0xf bound_ctrl:0
    v_min_u32_dpp v32, v34, v34 row_shr:1 row_mask:0xf bank_mask:0xf bound_ctrl:0
    v_max_u32_dpp v33, v35, v35 row_shr:1 row_mask:0xf bank_mask:0xf bound_ctrl:0
    v_max_u32 v41, v32, v33
    v_max_u32_dpp v34, v40, v40 row_shr:2 row_mask:0xf bank_mask:0xf bound_ctrl:0
    v_min_u32_dpp v32, v40, v40 row_shr:2 row_mask:0xf bank_mask:0xf bound_ctrl:0
    v_max_u32_dpp v33, v41, v41 row_shr:2 row_mask:0xf bank_mask:0xf bound_ctrl:0
    v_max_u32 v35, v32, v33
    v_max_u32_dpp v40, v34, v34 row_shr:4 row_mask:0xf bank_mask:0xf bound_ctrl:0
    v_min_u32_dpp v32, v34, v34 row_shr:4 row_mask:0xf bank_mask:0xf bound_ctrl:0
    v_max_u32_dpp v33, v35, v35 row_shr:4 row_mask:0xf bank_mask:0xf bound_ctrl:0
    v_max_u32 v41, v32, v33
    v_max_u32_dpp v34, v40, v40 row_shr:8 row_mask:0xf bank_mask:0xf bound_ctrl:0
    v_min_u32_dpp v32, v40, v40 row_shr:8 row_mask:0xf bank_mask:0xf bound_ctrl:0
    v_max_u32_dpp v33, v41, v41 row_shr:8 row_mask:0xf bank_mask:0xf bound_ctrl:0
    v_max_u32 v35, v32, v33
    v_max_u32_dpp v40, v34, v34 row_bcast:15 row_mask:0xa bank_mask:0xf
    v_min_u32_dpp v32, v34, v34 row_bcast:15 row_mask:0xa bank_mask:0xf
    v_max_u32_dpp v33, v35, v35 row_bcast:15 row_mask:0xa bank_mask:0xf
    v_max_u32 v41, v32, v33
    v_max_u32_dpp v34, v40, v40 row_bcast:31 row_mask:0xc bank_mask:0xf
    v_min_u32_dpp v32, v40, v40 row_bcast:31 row_mask:0xc bank_mask:0xf
    v_max_u32_dpp v33, v41, v41 row_bcast:31 row_mask:0xc bank_mask:0xf
    v_max_u32 v35, v32, v33
    v_readlane_b32 s64, v34, 63
    v_readlane_b32 s65, v35, 63
    s_mov_b32 vcc_hi, 0xaaaaaaaa
    s_cmp_lg_u32 s61, 1
    v_mov_b32 v38, s64
    s_cbranch_scc1 L_norow
    v_mov_b32 v37, s65
    s_mov_b32 s5, 0xffe0
    v_cndmask_b32 v38, v38, v37, vcc
    v_bitop3_b32 v38, v38, v38, s5 bitop3:0x02
    v_lshl_add_u32 v38, v38, 5, v26
    global_load_dwordx4 v[184:187], v38, s[8:9] offset:0
    global_load_dwordx4 v[188:191], v38, s[8:9] offset:128
L_norow:
    s_cmp_lg_u32 s4, 7
    s_cbranch_scc1 L_nosel
    v_mov_b32 v36, 1
    s_mov_b32 exec_lo, 0
    s_brev_b32 exec_hi, 1
    ds_write_b96 v14, v[34:36]
    s_cmp_lg_u32 s3, 28
    s_cbranch_scc1 L_noep
    v_mov_b32 v32, s48
    buffer_store_dword v32, off, s[40:43], 0 sc1
L_noep:
    s_mov_b64 exec, -1
L_nosel:
    s_bfe_u32 s5, s64, 0x2000e
    s_bfe_u32 s6, s64, 0x10004
    s_lshl1_add_u32 s5, s5, s6
    s_lshl_b32 s5, s5, 1
    s_set_gpr_idx_on s5, gpr_idx(SRC0)
    s_bfe_u32 s6, s64, 0x60008
    v_mov_b32 v32, v225
    s_set_gpr_idx_off
    v_readlane_b32 s22, v32, s6
    s_bfe_u32 s5, s65, 0x2000e
    s_bfe_u32 s6, s65, 0x10004
    s_lshl1_add_u32 s5, s5, s6
    s_lshl_b32 s5, s5, 1
    s_set_gpr_idx_on s5, gpr_idx(SRC0)
    s_bfe_u32 s6, s65, 0x60008
    v_mov_b32 v32, v225
    s_set_gpr_idx_off
    v_readlane_b32 s23, v32, s6
L_notop:
    s_cmp_lg_u32 s61, 1
    s_cbranch_scc1 L_role0
    v_and_b32 v62, s22, v3
    v_and_b32 v63, s23, v3
    v_rcp_f32 v62, v62
    v_rcp_f32 v63, v63
    v_lshlrev_b32 v60, 16, s22
    v_lshlrev_b32 v61, 16, s23
    s_mov_b32 s71, 0
L_fw17:
    ds_read_b32 v42, v14 offset:80
    s_add_u32 s71, s71, 1
    s_cmp_ge_u32 s71, 960000
    s_waitcnt lgkmcnt(0)
    s_cbranch_scc1 L_fw17x
    v_cmp_gt_u32 vcc, 1, v42
    s_cbranch_vccnz L_fw17
L_fw17x:
    v_readfirstlane_b32 s20, v42
    s_waitcnt vmcnt(1)
L_ffn:
    v_mfma_f32_16x16x32_bf16 v[200:203], v[184:187], v[64:67], 0
    v_mfma_f32_16x16x32_bf16 v[204:207], v[184:187], v[68:71], 0
    v_mfma_f32_16x16x32_bf16 v[208:211], v[184:187], v[80:83], 0
    v_mfma_f32_16x16x32_bf16 v[212:215], v[184:187], v[84:87], 0
    s_waitcnt vmcnt(0)
    v_mfma_f32_16x16x32_bf16 v[200:203], v[188:191], v[72:75], v[200:203]
    v_mfma_f32_16x16x32_bf16 v[204:207], v[188:191], v[76:79], v[204:207]
    v_mfma_f32_16x16x32_bf16 v[208:211], v[188:191], v[88:91], v[208:211]
    v_mfma_f32_16x16x32_bf16 v[212:215], v[188:191], v[92:95], v[212:215]
    s_mov_b64 exec, 0xffff
    s_cmp_lg_u32 s20, 1
    s_nop 2
    v_fma_f32 v44, -v60, v100, v200
    v_fma_f32 v45, -v61, v100, v201
    v_add_f32 v44, v44, v206
    v_add_f32 v45, v45, v207
    v_mul_f32 v44, v44, v62
    v_mul_f32 v45, v45, v63
    v_and_or_b32 v44, v44, v31, s10
    v_and_or_b32 v45, v45, v31, s11
    v_fma_f32 v46, -v60, v104, v208
    v_fma_f32 v47, -v61, v104, v209
    v_add_f32 v46, v46, v214
    v_add_f32 v47, v47, v215
    v_mul_f32 v46, v46, v62
    v_mul_f32 v47, v47, v63
    v_and_or_b32 v46, v46, v31, s12
    v_and_or_b32 v47, v47, v31, s13
    s_cbranch_scc1 L_pslow
    buffer_store_dwordx4 v[44:47], v166, s[40:43], 0 offen
L_pst:
    s_mov_b64 exec, -1
    s_mov_b32 s75, 0
    buffer_load_dwordx4 v[96:99], v167, s[40:43], s51 offen sc1
    buffer_load_dwordx4 v[100:103], v167, s[40:43], s51 offen offset:128 sc1
    s_waitcnt vmcnt(2)
    buffer_load_dwordx4 v[184:187], v167, s[40:43], s51 offen sc1
    buffer_load_dwordx4 v[188:191], v167, s[40:43], s51 offen offset:128 sc1
L_pp:
    s_waitcnt vmcnt(3)
    v_xor_b32 v42, s10, v96
    v_xor_b32 v43, s11, v97
    v_bitop3_b32 v42, v42, v98, s12 bitop3:0xf6
    v_bitop3_b32 v43, v43, v99, s13 bitop3:0xf6
    s_waitcnt vmcnt(2)
    v_add_f32 v32, v96, v100
    v_add_f32 v33, v97, v101
    v_bitop3_b32 v42, v42, v100, s10 bitop3:0xf6
    v_add_f32 v34, v98, v102
    v_cndmask_b32 v36, v33, v32, s[24:25]
    v_add_f32 v35, v99, v103
    v_cndmask_b32 v32, v32, v33, s[24:25]
    v_bitop3_b32 v43, v43, v101, s11 bitop3:0xf6
    s_nop 0
    v_add_f32_dpp v32, v36, v32 quad_perm:[1,0,3,2] row_mask:0xf bank_mask:0xf
    v_bitop3_b32 v42, v42, v102, s12 bitop3:0xf6
    v_cndmask_b32 v36, v35, v34, s[24:25]
    v_bitop3_b32 v43, v43, v103, s13 bitop3:0xf6
    v_cvt_pk_bf16_f32 v32, 0, v32
    v_bitop3_b32 v42, v42, v43, 63 bitop3:0xa8
    v_cndmask_b32 v33, v34, v35, s[24:25]
    v_cmp_ne_u32 vcc, 0, v42
    v_mul_f32 v34, 0xbfb8aa3b, v32
    s_cbranch_vccnz L_pret
L_pok:
    s_mov_b64 exec, 1
    ds_add_u32 v14, v39 offset:32
    s_mov_b64 exec, -1
    v_exp_f32 v34, v34
    v_add_f32_dpp v33, v36, v33 quad_perm:[1,0,3,2] row_mask:0xf bank_mask:0xf
    v_add_f32 v34, 1.0, v34
    v_rcp_f32 v34, v34
    v_cvt_pk_bf16_f32 v33, 0, v33
    v_mul_f32 v32, v32, v34
    v_cvt_pk_bf16_f32 v32, 0, v32
    v_mul_f32 v32, v32, v33
    s_mov_b32 s6, 0x00030003
    s_mov_b32 s7, 0x00030003
    v_mov_b32_dpp v33, v32 quad_perm:[2,3,2,3] row_mask:0xf bank_mask:0xf
    v_mov_b32_dpp v32, v32 quad_perm:[0,1,0,1] row_mask:0xf bank_mask:0xf
    v_cvt_pk_bf16_f32 v216, v32, v33
    s_waitcnt lgkmcnt(0)
    s_nop 0
    v_mov_b32_dpp v217, v216 row_ror:12 row_mask:0xf bank_mask:0xf
    v_mov_b32_dpp v218, v216 row_ror:8 row_mask:0xf bank_mask:0xf
    v_mov_b32_dpp v219, v216 row_ror:4 row_mask:0xf bank_mask:0xf
    s_nop 1
    v_mfma_f32_16x16x32_bf16 v[200:203], v[128:131], v[216:219], 0
    v_mfma_f32_16x16x32_bf16 v[204:207], v[132:135], v[216:219], 0
    v_mfma_f32_16x16x32_bf16 v[208:211], v[136:139], v[216:219], 0
    v_mfma_f32_16x16x32_bf16 v[212:215], v[140:143], v[216:219], 0
    s_nop 4
    v_and_or_b32 v44, v200, v31, s10
    v_and_or_b32 v45, v201, v31, s11
    v_and_or_b32 v46, v202, v31, s12
    v_and_or_b32 v47, v203, v31, s13
    s_lshl_b64 exec, s[6:7], 4
    v_and_or_b32 v44, v204, v31, s10
    v_and_or_b32 v45, v205, v31, s11
    v_and_or_b32 v46, v206, v31, s12
    v_and_or_b32 v47, v207, v31, s13
    s_lshl_b64 exec, s[6:7], 8
    v_and_or_b32 v44, v208, v31, s10
    v_and_or_b32 v45, v209, v31, s11
    v_and_or_b32 v46, v210, v31, s12
    v_and_or_b32 v47, v211, v31, s13
    s_lshl_b64 exec, s[6:7], 12
    v_and_or_b32 v44, v212, v31, s10
    v_and_or_b32 v45, v213, v31, s11
    v_and_or_b32 v46, v214, v31, s12
    v_and_or_b32 v47, v215, v31, s13
    s_mov_b64 exec, s[18:19]
    buffer_store_dwordx4 v[44:47], v165, s[40:43], s21 offen sc1
    s_mov_b64 exec, -1
    s_branch L_ffn_done
L_gxr:
    s_add_u32 s71, s71, 1
    s_cmp_ge_u32 s71, 60000
    s_cbranch_scc1 L_gxo
    buffer_load_dword v44, v161, s[40:43], 0 offen offset:2048 sc1
    s_branch L_gx
L_pollk_r:
    s_add_u32 s75, s75, 1
    s_cmp_ge_u32 s75, 60000
    s_cbranch_scc1 L_pollk_ok
    buffer_load_dwordx4 v[224:227], v25, s[40:43], s73 offen offset:0 sc1
    buffer_load_dwordx4 v[228:231], v25, s[40:43], s73 offen offset:1024 sc1
    buffer_load_dwordx4 v[232:235], v25, s[40:43], s73 offen offset:2048 sc1
    buffer_load_dwordx4 v[236:239], v25, s[40:43], s73 offen offset:3072 sc1
    s_waitcnt vmcnt(0)
    s_branch L_pollk
L_pslow:
    buffer_store_dwordx4 v[44:47], v166, s[40:43], 0 offen sc1
    s_branch L_pst
L_pret:
    buffer_load_dwordx4 v[96:99], v167, s[40:43], s51 offen sc1
    buffer_load_dwordx4 v[100:103], v167, s[40:43], s51 offen offset:128 sc1
    s_waitcnt vmcnt(3)
    v_xor_b32 v42, s10, v184
    v_xor_b32 v43, s11, v185
    v_bitop3_b32 v42, v42, v186, s12 bitop3:0xf6
    v_bitop3_b32 v43, v43, v187, s13 bitop3:0xf6
    s_waitcnt vmcnt(2)
    v_add_f32 v32, v184, v188
    v_add_f32 v33, v185, v189
    v_bitop3_b32 v42, v42, v188, s10 bitop3:0xf6
    v_add_f32 v34, v186, v190
    v_cndmask_b32 v36, v33, v32, s[24:25]
    v_add_f32 v35, v187, v191
    v_cndmask_b32 v32, v32, v33, s[24:25]
    v_bitop3_b32 v43, v43, v189, s11 bitop3:0xf6
    s_nop 0
    v_add_f32_dpp v32, v36, v32 quad_perm:[1,0,3,2] row_mask:0xf bank_mask:0xf
    v_bitop3_b32 v42, v42, v190, s12 bitop3:0xf6
    v_cndmask_b32 v36, v35, v34, s[24:25]
    v_bitop3_b32 v43, v43, v191, s13 bitop3:0xf6
    v_cvt_pk_bf16_f32 v32, 0, v32
    v_bitop3_b32 v42, v42, v43, 63 bitop3:0xa8
    v_cndmask_b32 v33, v34, v35, s[24:25]
    v_cmp_ne_u32 vcc, 0, v42
    v_mul_f32 v34, 0xbfb8aa3b, v32
    s_cbranch_vccz L_pok
    buffer_load_dwordx4 v[184:187], v167, s[40:43], s51 offen sc1
    buffer_load_dwordx4 v[188:191], v167, s[40:43], s51 offen offset:128 sc1
    s_add_u32 s75, s75, 1
    s_cmp_lt_u32 s75, 240000
    s_cbranch_scc1 L_pp
    s_branch L_pok
L_role0:
    s_setprio 0
    s_cmp_eq_u32 s4, 7
    s_cbranch_scc1 L_ffn_done
    s_mov_b32 s71, 0
L_fw18:
    ds_read_b32 v42, v14 offset:24
    s_add_u32 s71, s71, 1
    s_cmp_ge_u32 s71, 960000
    s_waitcnt lgkmcnt(0)
    s_cbranch_scc1 L_fw18x
    v_cmp_gt_u32 vcc, 4, v42
    s_cbranch_vccnz L_fw18
L_fw18x:
    s_and_b32 s5, s3, 31
    s_mul_i32 s5, s5, 196608
    s_and_b32 s6, s3, 0xe0
    s_lshl2_add_u32 s5, s6, s5
    s_and_b32 s6, s4, 1
    s_lshl_b32 s6, s6, 30
    s_add_u32 s5, s5, s6
    v_lshl_add_u32 v36, v16, 10, s5
    s_mov_b32 s52, s8
    s_mov_b32 s53, s9
    s_mov_b32 s54, 2097152
    s_mov_b32 s5, 0
    s_mov_b32 m0, 134080
    s_nop 0
    buffer_load_dwordx4 v56, s[52:55], s5 offen nt lds
    s_mov_b32 s5, 8192
    s_mov_b32 m0, 135104
    s_nop 0
    buffer_load_dwordx4 v56, s[52:55], s5 offen nt lds
    s_mov_b32 s5, 16384
    s_mov_b32 m0, 136128
    s_nop 0
    buffer_load_dwordx4 v56, s[52:55], s5 offen nt lds
    s_mov_b32 s5, 24576
    s_mov_b32 m0, 137152
    s_nop 0
    buffer_load_dwordx4 v56, s[52:55], s5 offen nt lds
    s_mov_b32 s5, 32768
    s_mov_b32 m0, 138176
    s_nop 0
    buffer_load_dwordx4 v56, s[52:55], s5 offen nt lds
    s_mov_b32 s5, 40960
    s_mov_b32 m0, 139200
    s_nop 0
    buffer_load_dwordx4 v56, s[52:55], s5 offen nt lds
    s_mov_b32 s5, 49152
    s_mov_b32 m0, 140224
    s_nop 0
    buffer_load_dwordx4 v56, s[52:55], s5 offen nt lds
    s_mov_b32 s5, 57344
    s_mov_b32 m0, 141248
    s_nop 0
    buffer_load_dwordx4 v56, s[52:55], s5 offen nt lds
    s_mov_b32 s5, 524288
    buffer_load_dword v120, v36, s[52:55], s5 offen
    s_mov_b32 s5, 589824
    buffer_load_dword v121, v36, s[52:55], s5 offen
    s_mov_b32 s5, 655360
    buffer_load_dword v122, v36, s[52:55], s5 offen
    v_mov_b32 v39, 2
    s_branch L_role0z
L_role0y:
    s_mov_b32 s52, s8
    s_mov_b32 s53, s9
    s_mov_b32 s54, 2097152
    s_and_b32 s6, s4, 1
    s_lshl_b32 s6, s6, 12
    s_mov_b32 s5, 0
    s_add_u32 m0, s6, 134080
    s_nop 0
    buffer_load_dwordx4 v56, s[52:55], s5 offen nt lds
    s_mov_b32 s5, 8192
    s_add_u32 m0, s6, 135104
    s_nop 0
    buffer_load_dwordx4 v56, s[52:55], s5 offen nt lds
    s_mov_b32 s5, 16384
    s_add_u32 m0, s6, 136128
    s_nop 0
    buffer_load_dwordx4 v56, s[52:55], s5 offen nt lds
    s_mov_b32 s5, 24576
    s_add_u32 m0, s6, 137152
    s_nop 0
    buffer_load_dwordx4 v56, s[52:55], s5 offen nt lds
L_role0z:
    s_mov_b32 s68, -1
L_ffn_done:
    s_setprio 0
    s_and_b32 s5, s3, 0x1c
    s_lshr_b32 s5, 0x75542200, s5
    s_and_b32 s5, s5, 7
    v_lshl_add_u32 v34, s5, 2, v14
    s_mov_b32 s52, s36
    s_mov_b32 s53, s37
    s_mov_b32 s54, 2097152
    v_add_u32 v168, -4096, v162
    v_add_u32 v169, -3072, v162
    v_add_u32 v170, -2048, v162
    v_add_u32 v171, -1024, v162
    v_add_u32 v172, 0, v162
    v_add_u32 v173, 1024, v162
    v_add_u32 v174, 2048, v162
    v_add_u32 v175, 3072, v162
    v_mov_b32 v66, 0
    v_mov_b32 v67, 0
    v_mov_b32 v65, 0
    s_mov_b32 s24, 0
    s_lshl2_add_u32 s61, s61, s4
    s_cmp_lg_u32 s61, 15
    s_cbranch_scc1 L_np
    s_lshr_b32 s5, s3, 5
    s_and_b32 s6, s3, 31
    s_lshl3_add_u32 s63, s5, s6
    v_lshrrev_b32 v36, 2, v16
    v_and_b32 v37, 3, v16
    v_lshlrev_b32 v36, 12, v36
    v_lshl_add_u32 v165, v37, 4, v36
    s_lshl_b32 s5, s63, 6
    s_add_u32 s21, s5, 1048576
    s_bfm_b64 s[18:19], 44, 0
    v_mov_b32 v104, s10
    v_mov_b32 v105, s11
    v_mov_b32 v106, s12
    v_mov_b32 v107, s13
    s_mov_b32 vcc_lo, 0xcccccccc
    s_mov_b32 vcc_hi, 0xcccccccc
    v_mov_b32 v32, s64
    v_mov_b32 v33, s65
    v_cndmask_b32 v32, v32, v33, vcc
    s_mov_b32 s5, 0xffe0
    v_bitop3_b32 v38, v32, v32, s5 bitop3:0x02
    v_and_b32 v36, 1, v16
    v_lshl_add_u32 v36, v36, 2, v27
    s_lshl_b32 s5, s63, 4
    v_lshl_add_u32 v37, v36, 1, s5
    v_lshl_add_u32 v65, v38, 5, v37
    global_load_ushort v69, v65, s[8:9]
    v_and_b32 v37, 0xfc00, v38
    v_lshrrev_b32 v37, 1, v37
    s_movk_i32 s5, 0x100
    v_and_or_b32 v37, v38, s5, v37
    v_and_b32 v33, 1, v36
    v_lshl_add_u32 v37, v33, 7, v37
    v_lshlrev_b32 v37, 3, v37
    v_and_b32 v33, 6, v36
    v_lshl_add_u32 v37, v33, 4, v37
    v_bfe_u32 v33, v38, 9, 1
    v_lshl_add_u32 v66, v33, 4, v37
    v_bfe_u32 v37, v38, 5, 3
    v_lshl_add_u32 v67, v37, 1, v66
    s_lshl_b32 s5, s63, 15
    s_mul_i32 s6, s6, -32640
    s_add_u32 s5, s5, s6
    s_add_u32 s24, s5, 2097152
    v_ashrrev_i32 v33, 31, v32
    s_brev_b32 s5, 1
    v_bitop3_b32 v32, v32, v33, s5 bitop3:0x4b
    v_and_b32 v32, v3, v32
    v_mul_f32 v32, 0xbfb8aa3b, v32
    v_exp_f32 v32, v32
    v_mov_b32 v40, s22
    v_mov_b32 v41, s23
    v_add_f32 v32, 1.0, v32
    v_cndmask_b32 v40, v40, v41, vcc
    v_rcp_f32 v32, v32
    v_and_b32 v41, v3, v40
    v_rcp_f32 v41, v41
    v_lshlrev_b32 v40, 16, v40
    v_cvt_pk_bf16_f32 v68, 0, v32
    v_mov_b32 v118, v40
    v_mov_b32 v119, v41
L_np:
    s_mov_b32 s71, 0
L_selw:
    ds_read_b96 v[36:38], v14
    s_add_u32 s71, s71, 1
    s_cmp_ge_u32 s71, 960000
    s_waitcnt lgkmcnt(0)
    s_cbranch_scc1 L_selok
    v_cmp_eq_u32 vcc, 0, v38
    s_cbranch_vccnz L_selw
L_selok:
    v_readfirstlane_b32 s64, v36
    v_readfirstlane_b32 s65, v37
    s_bfe_u32 s6, s64, 0x80008
    s_and_b32 s6, s6, 0xfd
    s_cmp_lg_u32 s50, s6
    s_cbranch_scc1 L_sk19
    s_bfe_u32 s6, s64, 0x30005
    s_sub_u32 s5, 7, s6
    s_bitcmp1_b32 s64, 9
    s_cselect_b32 exec_lo, -1, 0
    s_set_gpr_idx_on s5, gpr_idx(DST)
    s_cselect_b32 exec_hi, 0, -1
    v_mov_b32 v168, v3
    s_set_gpr_idx_off
    s_mov_b64 exec, -1
L_sk19:
    s_bfe_u32 s6, s65, 0x80008
    s_and_b32 s6, s6, 0xfd
    s_cmp_lg_u32 s50, s6
    s_cbranch_scc1 L_sk20
    s_bfe_u32 s6, s65, 0x30005
    s_sub_u32 s5, 7, s6
    s_bitcmp1_b32 s65, 9
    s_cselect_b32 exec_lo, -1, 0
    s_set_gpr_idx_on s5, gpr_idx(DST)
    s_cselect_b32 exec_hi, 0, -1
    v_mov_b32 v168, v3
    s_set_gpr_idx_off
    s_mov_b64 exec, -1
L_sk20:
    s_cmp_lg_u32 s68, -1
    s_cbranch_scc1 L_nxd
    s_waitcnt vmcnt(0)
    s_mov_b64 exec, 1
    ds_add_u32 v14, v39 offset:36
    s_mov_b64 exec, -1
L_nxd:
    s_mov_b32 s71, 0
L_fw21:
    ds_read_b32 v42, v34 offset:96
    s_add_u32 s71, s71, 1
    s_cmp_ge_u32 s71, 960000
    s_waitcnt lgkmcnt(0)
    s_cbranch_scc1 L_fw21x
    v_cmp_gt_u32 vcc, 1, v42
    s_cbranch_vccnz L_fw21
L_fw21x:
    buffer_load_dwordx4 v[48:51], v160, s[40:43], s57 offen offset:0 sc1
    buffer_load_dwordx4 v[52:55], v160, s[40:43], s57 offen offset:1024 sc1
    s_mov_b32 s71, 0
    s_mov_b64 vcc, -1
L_poll2:
    ds_read_b32 v42, v14 offset:36
    ds_read2_b32 v[176:177], v57 offset0:0 offset1:32
    ds_read2_b32 v[178:179], v57 offset0:64 offset1:96
    ds_read2_b32 v[180:181], v57 offset0:128 offset1:160
    ds_read2_b32 v[182:183], v57 offset0:192 offset1:224
    s_add_u32 s71, s71, 1
    s_cmp_lg_u32 s71, 1
    s_waitcnt lgkmcnt(0)
    v_lshlrev_b32 v144, 16, v176
    v_and_b32 v145, v3, v176
    v_lshlrev_b32 v146, 16, v177
    v_and_b32 v147, v3, v177
    v_lshlrev_b32 v148, 16, v178
    v_and_b32 v149, v3, v178
    v_lshlrev_b32 v150, 16, v179
    v_and_b32 v151, v3, v179
    v_lshlrev_b32 v152, 16, v180
    v_and_b32 v153, v3, v180
    v_lshlrev_b32 v154, 16, v181
    v_and_b32 v155, v3, v181
    v_lshlrev_b32 v156, 16, v182
    v_and_b32 v157, v3, v182
    v_lshlrev_b32 v158, 16, v183
    v_and_b32 v159, v3, v183
    v_readfirstlane_b32 s5, v42
    s_cbranch_scc1 L_yt
    s_waitcnt vmcnt(1)
    v_xor_b32 v48, s44, v48
    v_xor_b32 v49, s45, v49
    v_xor_b32 v50, s46, v50
    v_xor_b32 v51, s67, v51
    v_or3_b32 v35, v48, v49, v50
    s_waitcnt vmcnt(0)
    v_xor_b32 v52, s44, v52
    v_xor_b32 v53, s45, v53
    v_xor_b32 v54, s46, v54
    v_xor_b32 v55, s67, v55
    v_or3_b32 v36, v51, v52, v53
    v_or3_b32 v35, v35, v54, v55
    v_bitop3_b32 v35, v35, v36, v13 bitop3:0x54
    v_cmp_ne_u32 vcc, 0, v35
    s_cbranch_vccz L_nyl
    s_mov_b64 exec, vcc
    s_mov_b32 s5, 0
    buffer_load_dwordx4 v[72:75], v160, s[40:43], s57 offen offset:0 sc1
    buffer_load_dwordx4 v[76:79], v160, s[40:43], s57 offen offset:1024 sc1
L_nyl:
    s_mov_b64 exec, -1
    s_cmp_ge_u32 s71, 240000
    s_cselect_b32 s5, 2, s5
    s_cmp_lt_u32 s5, 2
    v_fma_mix_f32 v144, v48, 1.0, v144 op_sel:[0,0,0] op_sel_hi:[1,0,0]
    v_fma_mix_f32 v145, v52, 1.0, v145 op_sel:[0,0,0] op_sel_hi:[1,0,0]
    v_cvt_pk_bf16_f32 v88, v144, v145
    v_fma_mix_f32 v146, v48, 1.0, v146 op_sel:[1,0,0] op_sel_hi:[1,0,0]
    v_fma_mix_f32 v147, v52, 1.0, v147 op_sel:[1,0,0] op_sel_hi:[1,0,0]
    v_cvt_pk_bf16_f32 v89, v146, v147
    v_fma_mix_f32 v148, v49, 1.0, v148 op_sel:[0,0,0] op_sel_hi:[1,0,0]
    v_fma_mix_f32 v149, v53, 1.0, v149 op_sel:[0,0,0] op_sel_hi:[1,0,0]
    v_cvt_pk_bf16_f32 v90, v148, v149
    v_fma_mix_f32 v150, v49, 1.0, v150 op_sel:[1,0,0] op_sel_hi:[1,0,0]
    v_fma_mix_f32 v151, v53, 1.0, v151 op_sel:[1,0,0] op_sel_hi:[1,0,0]
    v_cvt_pk_bf16_f32 v91, v150, v151
    v_fma_mix_f32 v152, v50, 1.0, v152 op_sel:[0,0,0] op_sel_hi:[1,0,0]
    v_fma_mix_f32 v153, v54, 1.0, v153 op_sel:[0,0,0] op_sel_hi:[1,0,0]
    v_cvt_pk_bf16_f32 v92, v152, v153
    v_fma_mix_f32 v154, v50, 1.0, v154 op_sel:[1,0,0] op_sel_hi:[1,0,0]
    v_fma_mix_f32 v155, v54, 1.0, v155 op_sel:[1,0,0] op_sel_hi:[1,0,0]
    v_cvt_pk_bf16_f32 v93, v154, v155
    v_fma_mix_f32 v156, v51, 1.0, v156 op_sel:[0,0,0] op_sel_hi:[1,0,0]
    v_fma_mix_f32 v157, v55, 1.0, v157 op_sel:[0,0,0] op_sel_hi:[1,0,0]
    v_cvt_pk_bf16_f32 v94, v156, v157
    v_fma_mix_f32 v158, v51, 1.0, v158 op_sel:[1,0,0] op_sel_hi:[1,0,0]
    v_fma_mix_f32 v159, v55, 1.0, v159 op_sel:[1,0,0] op_sel_hi:[1,0,0]
    v_cvt_pk_bf16_f32 v95, v158, v159
    s_cbranch_scc1 L_poll2
    buffer_store_dword v88, v168, s[52:55], 0 offen
    buffer_store_dword v89, v169, s[52:55], 0 offen
    buffer_store_dword v90, v170, s[52:55], 0 offen
    buffer_store_dword v91, v171, s[52:55], 0 offen
    buffer_store_dword v92, v172, s[52:55], 0 offen
    buffer_store_dword v93, v173, s[52:55], 0 offen
    buffer_store_dword v94, v174, s[52:55], 0 offen
    buffer_store_dword v95, v175, s[52:55], 0 offen
    s_cmp_lg_u32 s61, 15
    s_cbranch_scc1 L_fin
    s_mov_b32 s71, 0
L_cw22:
    ds_read2_b32 v[42:43], v14 offset0:28 offset1:31
    s_add_u32 s71, s71, 1
    s_cmp_ge_u32 s71, 960000
    s_waitcnt lgkmcnt(0)
    s_cbranch_scc1 L_cw22x
    v_min_u32 v42, v42, v43
    v_cmp_gt_u32 vcc, 2, v42
    s_cbranch_vccnz L_cw22
L_cw22x:
    s_setprio 3
    s_add_u32 s6, s21, 0x10000
    s_add_u32 s7, s21, 0x20000
L_dp:
    buffer_load_dwordx4 v[96:99], v165, s[40:43], s21 offen sc1
    buffer_load_dwordx4 v[100:103], v165, s[40:43], s6 offen sc1
    buffer_load_dwordx4 v[112:115], v66, s[40:43], s24 offen sc1
    buffer_load_ushort v116, v67, s[40:43], s24 offen sc1
    s_and_b64 exec, exec, s[18:19]
    buffer_load_dwordx4 v[104:107], v165, s[40:43], s7 offen sc1
    s_mov_b64 exec, -1
    s_add_u32 s69, s69, 1
    s_cmp_gt_u32 s69, 1
    s_cbranch_scc1 L_dc
    v_lshlrev_b32 v69, 16, v69
    v_sub_f32 v70, v69, v118
    v_cvt_pk_bf16_f32 v70, 0, v70
    v_mul_f32 v70, v70, v119
    v_cvt_pk_bf16_f32 v70, 0, v70
L_dc:
    s_waitcnt vmcnt(4)
    v_xor_b32 v42, s10, v96
    v_xor_b32 v43, s11, v97
    v_bitop3_b32 v42, v42, v98, s12 bitop3:0xf6
    v_bitop3_b32 v43, v43, v99, s13 bitop3:0xf6
    s_waitcnt vmcnt(3)
    v_bitop3_b32 v42, v42, v100, s10 bitop3:0xf6
    v_bitop3_b32 v43, v43, v101, s11 bitop3:0xf6
    v_bitop3_b32 v42, v42, v102, s12 bitop3:0xf6
    v_bitop3_b32 v43, v43, v103, s13 bitop3:0xf6
    v_pk_add_f32 v[44:45], v[96:97], v[100:101]
    v_pk_add_f32 v[46:47], v[98:99], v[102:103]
    s_waitcnt vmcnt(1)
    v_xor_b32 v40, s44, v112
    v_xor_b32 v41, s45, v113
    v_and_b32 v38, v13, v116
    v_bitop3_b32 v40, v40, v114, s46 bitop3:0xf6
    v_bitop3_b32 v41, v41, v115, s67 bitop3:0xf6
    v_bitop3_b32 v40, v40, v41, v13 bitop3:0x54
    s_waitcnt vmcnt(0)
    v_pk_add_f32 v[44:45], v[44:45], v[104:105]
    v_pk_add_f32 v[46:47], v[46:47], v[106:107]
    v_bitop3_b32 v42, v42, v104, s10 bitop3:0xf6
    v_bitop3_b32 v43, v43, v105, s11 bitop3:0xf6
    v_permlane32_swap_b32 v44, v46
    v_permlane32_swap_b32 v45, v47
    v_bitop3_b32 v42, v42, v106, s12 bitop3:0xf6
    v_bitop3_b32 v43, v43, v107, s13 bitop3:0xf6
    v_pk_add_f32 v[44:45], v[44:45], v[46:47]
    v_bitop3_b32 v42, v42, v43, 63 bitop3:0xa8
    v_or_b32 v42, v42, v40
    v_permlane16_swap_b32 v44, v45
    v_cmp_ne_u32 vcc, 0, v42
    v_add_f32 v44, v44, v45
    s_nop 1
    v_add_f32_dpp v44, v44, v44 row_ror:8 row_mask:0xf bank_mask:0xf
    s_nop 1
    v_add_f32_dpp v44, v44, v44 row_ror:4 row_mask:0xf bank_mask:0xf
    v_cvt_pk_bf16_f32 v44, 0, v44
    v_mul_f32 v44, v44, v68
    v_cvt_pk_bf16_f32 v44, 0, v44
    v_add_f32 v44, v44, v70
    v_cvt_pk_bf16_f32 v44, 0, v44
    v_mul_f32 v45, 0xbfb8aa3b, v44
    v_exp_f32 v45, v45
    s_nop 0
    v_add_f32 v45, 1.0, v45
    v_rcp_f32 v45, v45
    s_nop 0
    v_mul_f32 v44, v44, v45
    v_cvt_pk_bf16_f32 v44, 0, v44
    v_fma_mix_f32 v46, v38, v44, 0 op_sel_hi:[1,0,0]
    v_cvt_pk_bf16_f32 v46, 0, v46
    v_add_f32 v46, v46, v69
    v_cvt_pk_bf16_f32 v46, 0, v46
    s_cbranch_vccz L_dok
    s_mov_b64 exec, vcc
    s_cmp_lt_u32 s69, 60000
    s_cbranch_scc1 L_dp
L_dok:
    s_mov_b32 exec_lo, 0x000f000f
    s_mov_b32 exec_hi, 0x000f000f
    global_store_short_d16_hi v65, v46, s[36:37]
    s_mov_b64 exec, -1
L_fin:
L_end:
    s_endpgm
L_yt:
    s_cbranch_vccz L_nyl
    s_mov_b64 exec, vcc
    buffer_load_dwordx4 v[80:83], v160, s[40:43], s57 offen offset:0 sc1
    buffer_load_dwordx4 v[84:87], v160, s[40:43], s57 offen offset:1024 sc1
L_ytt:
    s_waitcnt vmcnt(3)
    v_xor_b32 v48, s44, v72
    v_xor_b32 v49, s45, v73
    v_xor_b32 v50, s46, v74
    v_xor_b32 v51, s67, v75
    v_or3_b32 v35, v48, v49, v50
    s_waitcnt vmcnt(2)
    v_xor_b32 v52, s44, v76
    v_xor_b32 v53, s45, v77
    v_xor_b32 v54, s46, v78
    v_xor_b32 v55, s67, v79
    v_or3_b32 v36, v51, v52, v53
    v_or3_b32 v35, v35, v54, v55
    v_bitop3_b32 v35, v35, v36, v13 bitop3:0x54
    v_cmp_ne_u32 vcc, 0, v35
    s_cbranch_vccz L_nyl
    s_mov_b64 exec, vcc
    buffer_load_dwordx4 v[72:75], v160, s[40:43], s57 offen offset:0 sc1
    buffer_load_dwordx4 v[76:79], v160, s[40:43], s57 offen offset:1024 sc1
    s_waitcnt vmcnt(3)
    v_xor_b32 v48, s44, v80
    v_xor_b32 v49, s45, v81
    v_xor_b32 v50, s46, v82
    v_xor_b32 v51, s67, v83
    v_or3_b32 v35, v48, v49, v50
    s_waitcnt vmcnt(2)
    v_xor_b32 v52, s44, v84
    v_xor_b32 v53, s45, v85
    v_xor_b32 v54, s46, v86
    v_xor_b32 v55, s67, v87
    v_or3_b32 v36, v51, v52, v53
    v_or3_b32 v35, v35, v54, v55
    v_bitop3_b32 v35, v35, v36, v13 bitop3:0x54
    v_cmp_ne_u32 vcc, 0, v35
    s_cbranch_vccz L_nyl
    s_mov_b64 exec, vcc
    buffer_load_dwordx4 v[80:83], v160, s[40:43], s57 offen offset:0 sc1
    buffer_load_dwordx4 v[84:87], v160, s[40:43], s57 offen offset:1024 sc1
    s_add_u32 s71, s71, 1
    s_cmp_lt_u32 s71, 240000
    s_cbranch_scc1 L_ytt
    s_mov_b64 vcc, 0
    s_branch L_nyl
L_cw2:
    s_sub_u32 s49, 255, s3
    v_mov_b32 v13, 0xfff8fff8
    s_mov_b32 s68, 0
    v_mov_b32 v14, 83712
    s_mov_b32 s75, 0
    s_and_b32 s5, s4, 1
    s_mul_i32 s71, s5, 12032
    s_add_u32 s71, s71, 76416
    v_and_b32 v32, 15, v16
    v_lshrrev_b32 v34, 4, v16
    s_mul_i32 s7, s5, 31552
    v_lshl_add_u32 v37, v34, 4, s7
    s_and_b32 s6, s4, 2
    v_mov_b32 v38, 544
    s_lshl_b32 s6, s6, 7
    v_mad_u32_u24 v20, v32, v38, v37
    s_add_u32 s14, s7, s6
    v_mul_u32_u24 v23, 1598, v33
    s_lshl_b32 s6, s5, 4
    v_lshrrev_b32 v39, 2, v16
    s_sub_u32 s17, 16, s6
    v_lshl_add_u32 v23, v39, 1, v23
    v_add_u32 v23, s71, v23
    v_add_u32 v1, s6, v14
    s_mov_b32 m0, s14
    v_and_b32 v36, 7, v0
    v_lshlrev_b32 v36, 2, v36
    s_mov_b32 s6, 0x43222100
    v_bfe_u32 v36, s6, v36, 3
    v_bfe_u32 v39, v16, 3, 1
    v_mad_u32_u24 v36, v39, 5, v36
    v_mad_u32_u24 v19, v36, v38, v37
    s_cmp_ge_u32 s4, 2
    s_cselect_b32 s6, 544, 32
    s_add_u32 s6, s6, s71
    v_lshrrev_b32 v39, 1, v34
    v_lshl_add_u32 v36, v39, 8, s6
    v_lshl_add_u32 v36, v32, 4, v36
    v_and_b32 v37, 1, v34
    v_lshl_add_u32 v21, v37, 3, v36
    v_add_u32 v22, 3196, v21
    v_and_b32 v36, 14, v32
    v_add_u32 v36, v36, v39
    v_lshlrev_b32 v36, 11, v36
    v_and_b32 v26, 1, v32
    v_lshl_add_u32 v36, v26, 4, v36
    s_mov_b32 s7, 163840
    v_lshl_add_u32 v26, v37, 30, v36
    v_lshl_add_u32 v7, v37, 15, v36
    s_movk_i32 s7, 5120
    v_lshl_add_u32 v4, v16, 2, s7
    s_mov_b32 s7, 83712
    v_writelane_b32 v4, s7, 0
    v_mov_b32 v6, 1
    v_lshl_add_u32 v12, s5, 2, v14
    s_lshl_b32 s6, s5, 12
    s_add_u32 s6, s6, 100480
    v_lshl_add_u32 v36, v34, 3, s6
    v_lshl_add_u32 v5, v32, 5, v36
    s_and_b32 s6, s3, 0xfc
    s_lshl_b32 s6, s6, 13
    s_and_b32 s7, s3, 3
    s_lshl2_add_u32 s7, s5, s7
    s_lshl_b32 s7, s7, 5
    s_add_u32 s6, s6, s7
    s_and_b32 s6, s3, 0xe0
    s_lshl3_add_u32 s6, s6, s5
    s_lshl_b32 s6, s6, 5
    s_and_b32 s7, s3, 31
    s_add_u32 s6, s6, s7
    s_lshl_b32 s6, s6, 5
    s_add_u32 s58, s6, 2097152
    v_mov_b32 v8, 0
    v_mov_b32 v9, 0
    v_mov_b32 v10, 0
    v_mov_b32 v11, 0
    s_mov_b32 s61, 0
    v_add_u32 v36, 1, v32
    v_and_b32 v37, 3, v36
    v_sub_u32 v36, v36, v37
    v_lshl_add_u32 v36, v34, 3, v36
    v_mul_u32_u24 v37, 1600, v37
    v_lshl_add_u32 v36, v36, 1, v37
    v_add_u32 v24, s71, v36
    v_lshlrev_b32 v36, 4, v34
    s_add_u32 s6, s71, 6448
    v_sub_u32 v36, s6, v36
    v_lshl_add_u32 v25, v32, 5, v36
    v_lshl_add_u32 v27, v32, 4, v36
    v_lshl_add_u32 v28, v32, 3, v36
    v_lshl_add_u32 v29, v32, 2, v36
    v_lshrrev_b32 v36, 1, v16
    v_and_b32 v37, 1, v16
    v_lshlrev_b32 v39, 10, v36
    v_lshl_add_u32 v30, v37, 4, v39
    v_mul_u32_u24 v37, 12032, v37
    v_lshl_add_u32 v37, v36, 4, v37
    s_xor_b32 s7, s4, s3
    s_mov_b32 s7, s4
    s_lshl_b32 s6, s7, 10
    s_add_u32 s6, s6, 84352
    v_add_u32 v31, s6, v37
    s_and_b32 s5, s3, 0xe0
    s_lshl3_add_u32 s5, s7, s5
    s_lshl_b32 s5, s5, 13
    s_and_b32 s6, s3, 31
    s_lshl_b32 s6, s6, 5
    s_add_u32 s5, s5, s6
    s_add_u32 s51, s5, 2097152
    v_mov_b32 v36, 0x3fb8aa3b
    v_mov_b32 v38, 0x3c00
    v_mov_b32 v39, 1
    s_mov_b32 vcc_lo, 0xffff0000
    s_mov_b32 vcc_hi, 0xffff0000
    ds_write_addtid_b32 v38 offset:36160
    s_waitcnt lgkmcnt(0)
    s_lshl_b32 s59, s59, s17
    s_and_b32 s59, s59, 0xffff0000
    v_mul_f32 v35, s59, v36
    v_exp_f32 v35, v35
    s_add_u32 s48, s48, 1
    s_and_b32 s44, s48, 0x00070007
    s_lshr_b32 s45, s48, 3
    s_and_b32 s45, s45, 0x00070007
    s_lshr_b32 s46, s48, 6
    s_and_b32 s46, s46, 0x00070007
    s_lshr_b32 s47, s48, 9
    s_and_b32 s47, s47, 0x00070007
    v_cvt_pk_bf16_f32 v34, 0, v35
    v_mul_f32 v32, v36, v34
    v_mul_f32 v33, 0x3e22f983, v34
    v_mul_f32 v56, 0x42000000, v32
    v_mul_f32 v57, 0x42000000, v33
    v_mov_b32 v36, s44
    v_mov_b32 v37, s46
    v_cndmask_b32 v17, v36, v37, vcc
    v_mov_b32 v36, s45
    s_xor_b32 s6, s47, 262144
    v_mov_b32 v37, s6
    v_cndmask_b32 v2, v36, v37, vcc
    s_lshl_b32 s66, s66, s17
    s_and_b32 s66, s66, 0xffff0000
    s_getreg_b32 s6, hwreg(HW_REG_XCC_ID, 0, 4)
    s_lshl_b32 s6, s6, 28
    s_xor_b32 s60, s48, s6
    v_mov_b32 v36, s60
    s_lshl2_add_u32 s6, s3, 2048
    s_cmp_eq_u32 s4, 0
    s_cselect_b64 exec, 1, 0
    buffer_store_dword v36, off, s[40:43], s6 sc1
    s_mov_b64 exec, -1
    s_cmp_ge_u32 s4, 2
    s_cselect_b64 vcc, -1, 0
    s_cselect_b32 s6, 256, 0
    s_cselect_b32 s7, 0, 256
    s_cselect_b32 s66, 0, s66
    v_writelane_b32 v8, s66, 0
    v_add_u32 v19, 8704, v19
    v_cndmask_b32 v36, v20, v19, vcc
    v_add_u32 v19, s6, v36
    v_add_u32 v58, s7, v36
    v_add_u32 v59, s7, v20
    v_add_u32 v20, s6, v20
    ds_read_b64 v[196:197], v24 offset:1088
    ds_read_b64 v[198:199], v24 offset:1096
    ds_read_b64 v[200:201], v24 offset:1152
    ds_read_b64 v[202:203], v24 offset:1160
    ds_read_b64 v[204:205], v24 offset:1216
    ds_read_b64 v[206:207], v24 offset:1224
    ds_read_b64 v[208:209], v24 offset:1280
    ds_read_b64 v[210:211], v24 offset:1288
    s_mov_b64 exec, 1
    ds_add_u32 v14, v39 offset:44
    s_mov_b64 exec, -1
    s_setprio 1
    s_cmp_ge_u32 s4, 2
    s_cbranch_scc1 L_stubY
L_stubYr:
    s_waitcnt vmcnt(5)
    v_pk_mul_f32 v[128:129], v[40:41], v[32:33]
    v_fract_f32 v129, v129
    v_exp_f32 v132, v128
    v_cos_f32 v134, v129
    v_sin_f32 v135, v129
    s_nop 0
    v_pk_mul_f32 v[134:135], v[134:135], v[132:133] op_sel:[0,0] op_sel_hi:[1,0]
    v_pk_mul_f32 v[138:139], v[134:135], v[134:135] op_sel:[0,0] op_sel_hi:[1,0]
    v_pk_fma_f32 v[138:139], v[134:135], v[134:135], v[138:139] op_sel:[1,1,0] op_sel_hi:[0,1,1] neg_lo:[1,0,0]
    v_pk_mul_f32 v[140:141], v[138:139], v[138:139] op_sel:[0,0] op_sel_hi:[1,0]
    v_pk_fma_f32 v[140:141], v[138:139], v[138:139], v[140:141] op_sel:[1,1,0] op_sel_hi:[0,1,1] neg_lo:[1,0,0]
    v_pk_mul_f32 v[142:143], v[140:141], v[140:141] op_sel:[0,0] op_sel_hi:[1,0]
    v_pk_fma_f32 v[142:143], v[140:141], v[140:141], v[142:143] op_sel:[1,1,0] op_sel_hi:[0,1,1] neg_lo:[1,0,0]
    v_cvt_pk_f16_f32 v144, v142, -v143
    v_pk_mul_f32 v[146:147], v[142:143], v[142:143] op_sel:[0,0] op_sel_hi:[1,0]
    v_pk_fma_f32 v[146:147], v[142:143], v[142:143], v[146:147] op_sel:[1,1,0] op_sel_hi:[0,1,1] neg_lo:[1,0,0]
    v_cvt_pk_f16_f32 v148, v146, -v147
    v_pk_mul_f32 v[150:151], v[146:147], v[146:147] op_sel:[0,0] op_sel_hi:[1,0]
    v_pk_fma_f32 v[150:151], v[146:147], v[146:147], v[150:151] op_sel:[1,1,0] op_sel_hi:[0,1,1] neg_lo:[1,0,0]
    v_cvt_pk_f16_f32 v152, v150, -v151
    v_pk_mul_f32 v[154:155], v[150:151], v[150:151] op_sel:[0,0] op_sel_hi:[1,0]
    v_pk_fma_f32 v[154:155], v[150:151], v[150:151], v[154:155] op_sel:[1,1,0] op_sel_hi:[0,1,1] neg_lo:[1,0,0]
    v_cvt_pk_f16_f32 v156, v154, -v155
    ds_write_addtid_b32 v144 offset:36704
    ds_write_addtid_b32 v148 offset:37248
    ds_write_addtid_b32 v152 offset:38336
    ds_write_addtid_b32 v156 offset:40512
    v_pk_mul_f16 v157, v148, v144 op_sel:[0,0] op_sel_hi:[1,0]
    v_pk_fma_f16 v157, v148, v144, v157 op_sel:[1,1,0] op_sel_hi:[0,1,1] neg_lo:[1,0,0]
    v_pk_mul_f16 v158, v152, v144 op_sel:[0,0] op_sel_hi:[1,0]
    v_pk_fma_f16 v158, v152, v144, v158 op_sel:[1,1,0] op_sel_hi:[0,1,1] neg_lo:[1,0,0]
    v_pk_mul_f16 v159, v152, v148 op_sel:[0,0] op_sel_hi:[1,0]
    v_pk_fma_f16 v159, v152, v148, v159 op_sel:[1,1,0] op_sel_hi:[0,1,1] neg_lo:[1,0,0]
    v_pk_mul_f16 v160, v152, v157 op_sel:[0,0] op_sel_hi:[1,0]
    v_pk_fma_f16 v160, v152, v157, v160 op_sel:[1,1,0] op_sel_hi:[0,1,1] neg_lo:[1,0,0]
    ds_write_addtid_b32 v157 offset:37792
    ds_write_addtid_b32 v158 offset:38880
    ds_write_addtid_b32 v159 offset:39424
    ds_write_addtid_b32 v160 offset:39968
    v_pk_mul_f16 v161, v156, v144 op_sel:[0,0] op_sel_hi:[1,0]
    v_pk_fma_f16 v161, v156, v144, v161 op_sel:[1,1,0] op_sel_hi:[0,1,1] neg_lo:[1,0,0]
    v_pk_mul_f16 v162, v156, v148 op_sel:[0,0] op_sel_hi:[1,0]
    v_pk_fma_f16 v162, v156, v148, v162 op_sel:[1,1,0] op_sel_hi:[0,1,1] neg_lo:[1,0,0]
    v_pk_mul_f16 v163, v156, v157 op_sel:[0,0] op_sel_hi:[1,0]
    v_pk_fma_f16 v163, v156, v157, v163 op_sel:[1,1,0] op_sel_hi:[0,1,1] neg_lo:[1,0,0]
    v_pk_mul_f16 v164, v156, v152 op_sel:[0,0] op_sel_hi:[1,0]
    v_pk_fma_f16 v164, v156, v152, v164 op_sel:[1,1,0] op_sel_hi:[0,1,1] neg_lo:[1,0,0]
    ds_write_addtid_b32 v161 offset:41056
    ds_write_addtid_b32 v162 offset:41600
    ds_write_addtid_b32 v163 offset:42144
    ds_write_addtid_b32 v164 offset:42688
    v_pk_mul_f16 v165, v156, v158 op_sel:[0,0] op_sel_hi:[1,0]
    v_pk_fma_f16 v165, v156, v158, v165 op_sel:[1,1,0] op_sel_hi:[0,1,1] neg_lo:[1,0,0]
    v_pk_mul_f16 v166, v156, v159 op_sel:[0,0] op_sel_hi:[1,0]
    v_pk_fma_f16 v166, v156, v159, v166 op_sel:[1,1,0] op_sel_hi:[0,1,1] neg_lo:[1,0,0]
    v_pk_mul_f16 v167, v156, v160 op_sel:[0,0] op_sel_hi:[1,0]
    v_pk_fma_f16 v167, v156, v160, v167 op_sel:[1,1,0] op_sel_hi:[0,1,1] neg_lo:[1,0,0]
    s_waitcnt vmcnt(1)
    v_pk_mul_f32 v[168:169], v[44:45], v[42:43] op_sel:[0,0] op_sel_hi:[1,0]
    v_pk_fma_f32 v[168:169], v[44:45], v[42:43], v[168:169] op_sel:[1,1,0] op_sel_hi:[0,1,1] neg_lo:[1,0,0]
    v_pk_mul_f32 v[168:169], v[168:169], v[34:35] op_sel_hi:[1,0]
    v_cvt_pk_f16_f32 v170, v168, v169
    ds_write_addtid_b32 v165 offset:43232
    ds_write_addtid_b32 v166 offset:43776
    ds_write_addtid_b32 v167 offset:44320
    ds_write_addtid_b32 v170 offset:13312
    v_cvt_pk_f16_f32 v171, v134, v135
    v_pk_mul_f16 v172, v170, v171 op_sel:[0,0] op_sel_hi:[1,0]
    v_pk_fma_f16 v172, v170, v171, v172 op_sel:[1,1,0] op_sel_hi:[0,1,1] neg_lo:[1,0,0]
    v_cvt_pk_f16_f32 v173, v138, v139
    v_pk_mul_f16 v174, v170, v173 op_sel:[0,0] op_sel_hi:[1,0]
    v_pk_fma_f16 v174, v170, v173, v174 op_sel:[1,1,0] op_sel_hi:[0,1,1] neg_lo:[1,0,0]
    v_pk_mul_f16 v175, v172, v173 op_sel:[0,0] op_sel_hi:[1,0]
    v_pk_fma_f16 v175, v172, v173, v175 op_sel:[1,1,0] op_sel_hi:[0,1,1] neg_lo:[1,0,0]
    v_cvt_pk_f16_f32 v176, v140, v141
    v_pk_mul_f16 v177, v170, v176 op_sel:[0,0] op_sel_hi:[1,0]
    v_pk_fma_f16 v177, v170, v176, v177 op_sel:[1,1,0] op_sel_hi:[0,1,1] neg_lo:[1,0,0]
    ds_write_addtid_b32 v172 offset:13856
    ds_write_addtid_b32 v174 offset:14400
    ds_write_addtid_b32 v175 offset:14944
    ds_write_addtid_b32 v177 offset:15488
    v_pk_mul_f16 v178, v172, v176 op_sel:[0,0] op_sel_hi:[1,0]
    v_pk_fma_f16 v178, v172, v176, v178 op_sel:[1,1,0] op_sel_hi:[0,1,1] neg_lo:[1,0,0]
    v_pk_mul_f16 v179, v174, v176 op_sel:[0,0] op_sel_hi:[1,0]
    v_pk_fma_f16 v179, v174, v176, v179 op_sel:[1,1,0] op_sel_hi:[0,1,1] neg_lo:[1,0,0]
    v_pk_mul_f16 v180, v175, v176 op_sel:[0,0] op_sel_hi:[1,0]
    v_pk_fma_f16 v180, v175, v176, v180 op_sel:[1,1,0] op_sel_hi:[0,1,1] neg_lo:[1,0,0]
    v_pk_mul_f32 v[182:183], v[154:155], v[154:155] op_sel:[0,0] op_sel_hi:[1,0]
    v_pk_fma_f32 v[182:183], v[154:155], v[154:155], v[182:183] op_sel:[1,1,0] op_sel_hi:[0,1,1] neg_lo:[1,0,0]
    v_cvt_pk_f16_f32 v184, v182, v183
    v_pk_mul_f16 v185, v170, v184 op_sel:[0,0] op_sel_hi:[1,0]
    v_pk_fma_f16 v185, v170, v184, v185 op_sel:[1,1,0] op_sel_hi:[0,1,1] neg_lo:[1,0,0]
    ds_write_addtid_b32 v178 offset:16032
    ds_write_addtid_b32 v179 offset:16576
    ds_write_addtid_b32 v180 offset:17120
    ds_write_addtid_b32 v185 offset:17664
    v_pk_mul_f16 v186, v172, v184 op_sel:[0,0] op_sel_hi:[1,0]
    v_pk_fma_f16 v186, v172, v184, v186 op_sel:[1,1,0] op_sel_hi:[0,1,1] neg_lo:[1,0,0]
    v_pk_mul_f16 v187, v174, v184 op_sel:[0,0] op_sel_hi:[1,0]
    v_pk_fma_f16 v187, v174, v184, v187 op_sel:[1,1,0] op_sel_hi:[0,1,1] neg_lo:[1,0,0]
    v_pk_mul_f16 v188, v175, v184 op_sel:[0,0] op_sel_hi:[1,0]
    v_pk_fma_f16 v188, v175, v184, v188 op_sel:[1,1,0] op_sel_hi:[0,1,1] neg_lo:[1,0,0]
    v_pk_mul_f16 v189, v177, v184 op_sel:[0,0] op_sel_hi:[1,0]
    v_pk_fma_f16 v189, v177, v184, v189 op_sel:[1,1,0] op_sel_hi:[0,1,1] neg_lo:[1,0,0]
    ds_write_addtid_b32 v186 offset:18208
    ds_write_addtid_b32 v187 offset:18752
    ds_write_addtid_b32 v188 offset:19296
    ds_write_addtid_b32 v189 offset:19840
    v_pk_mul_f16 v190, v178, v184 op_sel:[0,0] op_sel_hi:[1,0]
    v_pk_fma_f16 v190, v178, v184, v190 op_sel:[1,1,0] op_sel_hi:[0,1,1] neg_lo:[1,0,0]
    v_pk_mul_f16 v191, v179, v184 op_sel:[0,0] op_sel_hi:[1,0]
    v_pk_fma_f16 v191, v179, v184, v191 op_sel:[1,1,0] op_sel_hi:[0,1,1] neg_lo:[1,0,0]
    v_pk_mul_f16 v192, v180, v184 op_sel:[0,0] op_sel_hi:[1,0]
    v_pk_fma_f16 v192, v180, v184, v192 op_sel:[1,1,0] op_sel_hi:[0,1,1] neg_lo:[1,0,0]
    v_pk_mul_f32 v[194:195], v[182:183], v[182:183] op_sel:[0,0] op_sel_hi:[1,0]
    v_pk_fma_f32 v[194:195], v[182:183], v[182:183], v[194:195] op_sel:[1,1,0] op_sel_hi:[0,1,1] neg_lo:[1,0,0]
    v_cvt_pk_f16_f32 v212, v194, v195
    v_pk_mul_f16 v213, v170, v212 op_sel:[0,0] op_sel_hi:[1,0]
    v_pk_fma_f16 v213, v170, v212, v213 op_sel:[1,1,0] op_sel_hi:[0,1,1] neg_lo:[1,0,0]
    ds_write_addtid_b32 v190 offset:20384
    ds_write_addtid_b32 v191 offset:20928
    ds_write_addtid_b32 v192 offset:21472
    ds_write_addtid_b32 v213 offset:22016
    v_pk_mul_f16 v214, v174, v212 op_sel:[0,0] op_sel_hi:[1,0]
    v_pk_fma_f16 v214, v174, v212, v214 op_sel:[1,1,0] op_sel_hi:[0,1,1] neg_lo:[1,0,0]
    v_pk_mul_f16 v215, v177, v212 op_sel:[0,0] op_sel_hi:[1,0]
    v_pk_fma_f16 v215, v177, v212, v215 op_sel:[1,1,0] op_sel_hi:[0,1,1] neg_lo:[1,0,0]
    v_pk_mul_f16 v216, v179, v212 op_sel:[0,0] op_sel_hi:[1,0]
    v_pk_fma_f16 v216, v179, v212, v216 op_sel:[1,1,0] op_sel_hi:[0,1,1] neg_lo:[1,0,0]
    v_pk_mul_f16 v217, v185, v212 op_sel:[0,0] op_sel_hi:[1,0]
    v_pk_fma_f16 v217, v185, v212, v217 op_sel:[1,1,0] op_sel_hi:[0,1,1] neg_lo:[1,0,0]
    ds_write_addtid_b32 v214 offset:22560
    ds_write_addtid_b32 v215 offset:23104
    ds_write_addtid_b32 v216 offset:23648
    ds_write_addtid_b32 v217 offset:24736
    v_pk_mul_f16 v218, v187, v212 op_sel:[0,0] op_sel_hi:[1,0]
    v_pk_fma_f16 v218, v187, v212, v218 op_sel:[1,1,0] op_sel_hi:[0,1,1] neg_lo:[1,0,0]
    v_pk_mul_f16 v219, v189, v212 op_sel:[0,0] op_sel_hi:[1,0]
    v_pk_fma_f16 v219, v189, v212, v219 op_sel:[1,1,0] op_sel_hi:[0,1,1] neg_lo:[1,0,0]
    v_pk_mul_f16 v220, v191, v212 op_sel:[0,0] op_sel_hi:[1,0]
    v_pk_fma_f16 v220, v191, v212, v220 op_sel:[1,1,0] op_sel_hi:[0,1,1] neg_lo:[1,0,0]
    v_pk_mul_f16 v221, v213, v144 op_sel:[0,0] op_sel_hi:[1,0]
    v_pk_fma_f16 v221, v213, v144, v221 op_sel:[1,1,0] op_sel_hi:[0,1,1] neg_hi:[1,0,0]
    ds_write_addtid_b32 v218 offset:25280
    ds_write_addtid_b32 v219 offset:25824
    ds_write_addtid_b32 v220 offset:26368
    ds_write_addtid_b32 v221 offset:24192
    v_pk_mul_f16 v222, v217, v144 op_sel:[0,0] op_sel_hi:[1,0]
    v_pk_fma_f16 v222, v217, v144, v222 op_sel:[1,1,0] op_sel_hi:[0,1,1] neg_hi:[1,0,0]
    ds_write_addtid_b32 v222 offset:26912
    s_mov_b64 exec, 1
    ds_add_u32 v1, v39 offset:48
    s_mov_b64 exec, -1
    ds_read_b128 v[64:67], v19 offset:13312
    ds_read_b128 v[68:71], v20 offset:36160
    ds_read_b128 v[72:75], v19 offset:13376
    ds_read_b128 v[76:79], v20 offset:36224
    ds_read_b128 v[80:83], v19 offset:13440
    ds_read_b128 v[84:87], v20 offset:36288
    ds_read_b128 v[88:91], v19 offset:13504
    ds_read_b128 v[92:95], v20 offset:36352
    v_pk_mul_f16 v223, v221, v212 op_sel:[0,0] op_sel_hi:[1,0]
    v_pk_fma_f16 v223, v221, v212, v223 op_sel:[1,1,0] op_sel_hi:[0,1,1] neg_lo:[1,0,0]
    v_pk_mul_f16 v224, v222, v212 op_sel:[0,0] op_sel_hi:[1,0]
    v_pk_fma_f16 v224, v222, v212, v224 op_sel:[1,1,0] op_sel_hi:[0,1,1] neg_lo:[1,0,0]
    v_pk_mul_f32 v[226:227], v[194:195], v[194:195] op_sel:[0,0] op_sel_hi:[1,0]
    v_pk_fma_f32 v[226:227], v[194:195], v[194:195], v[226:227] op_sel:[1,1,0] op_sel_hi:[0,1,1] neg_lo:[1,0,0]
    v_cvt_pk_f16_f32 v228, v226, v227
    v_pk_mul_f16 v229, v177, v228 op_sel:[0,0] op_sel_hi:[1,0]
    v_pk_fma_f16 v229, v177, v228, v229 op_sel:[1,1,0] op_sel_hi:[0,1,1] neg_lo:[1,0,0]
    v_pk_mul_f16 v230, v189, v228 op_sel:[0,0] op_sel_hi:[1,0]
    v_pk_fma_f16 v230, v189, v228, v230 op_sel:[1,1,0] op_sel_hi:[0,1,1] neg_lo:[1,0,0]
    ds_write_addtid_b32 v223 offset:27456
    ds_write_addtid_b32 v224 offset:28544
    ds_write_addtid_b32 v229 offset:28000
    ds_write_addtid_b32 v230 offset:29088
    v_pk_mul_f16 v231, v215, v228 op_sel:[0,0] op_sel_hi:[1,0]
    v_pk_fma_f16 v231, v215, v228, v231 op_sel:[1,1,0] op_sel_hi:[0,1,1] neg_lo:[1,0,0]
    v_pk_mul_f16 v232, v221, v228 op_sel:[0,0] op_sel_hi:[1,0]
    v_pk_fma_f16 v232, v221, v228, v232 op_sel:[1,1,0] op_sel_hi:[0,1,1] neg_lo:[1,0,0]
    v_pk_mul_f16 v233, v219, v228 op_sel:[0,0] op_sel_hi:[1,0]
    v_pk_fma_f16 v233, v219, v228, v233 op_sel:[1,1,0] op_sel_hi:[0,1,1] neg_lo:[1,0,0]
    v_pk_mul_f16 v234, v222, v228 op_sel:[0,0] op_sel_hi:[1,0]
    v_pk_fma_f16 v234, v222, v228, v234 op_sel:[1,1,0] op_sel_hi:[0,1,1] neg_lo:[1,0,0]
    ds_write_addtid_b32 v231 offset:30176
    ds_write_addtid_b32 v232 offset:29632
    ds_write_addtid_b32 v233 offset:31264
    ds_write_addtid_b32 v234 offset:30720
    s_waitcnt lgkmcnt(8)
    ds_read_b32 v44, v1 offset:48
    ds_read_b128 v[96:99], v58 offset:13312
    ds_read_b128 v[100:103], v59 offset:36160
    ds_read_b128 v[104:107], v58 offset:13376
    ds_read_b128 v[108:111], v59 offset:36224
    ds_read_b128 v[112:115], v58 offset:13440
    ds_read_b128 v[116:119], v59 offset:36288
    ds_read_b128 v[120:123], v58 offset:13504
    ds_read_b128 v[124:127], v59 offset:36352
    v_pk_mul_f16 v235, v223, v228 op_sel:[0,0] op_sel_hi:[1,0]
    v_mfma_f32_16x16x32_f16 v[40:43], v[64:67], v[68:71], v[8:11]
    v_pk_fma_f16 v235, v223, v228, v235 op_sel:[1,1,0] op_sel_hi:[0,1,1] neg_lo:[1,0,0]
    v_pk_mul_f16 v236, v224, v228 op_sel:[0,0] op_sel_hi:[1,0]
    v_mfma_f32_16x16x32_f16 v[40:43], v[72:75], v[76:79], v[40:43]
    v_pk_fma_f16 v236, v224, v228, v236 op_sel:[1,1,0] op_sel_hi:[0,1,1] neg_lo:[1,0,0]
    v_pk_mul_f16 v237, v232, v228 op_sel:[0,0] op_sel_hi:[1,0]
    v_mfma_f32_16x16x32_f16 v[40:43], v[80:83], v[84:87], v[40:43]
    v_pk_fma_f16 v237, v232, v228, v237 op_sel:[1,1,0] op_sel_hi:[0,1,1] neg_lo:[1,0,0]
    v_pk_mul_f16 v238, v234, v228 op_sel:[0,0] op_sel_hi:[1,0]
    v_mfma_f32_16x16x32_f16 v[40:43], v[88:91], v[92:95], v[40:43]
    v_pk_fma_f16 v238, v234, v228, v238 op_sel:[1,1,0] op_sel_hi:[0,1,1] neg_lo:[1,0,0]
    ds_write_addtid_b32 v235 offset:31808
    ds_write_addtid_b32 v236 offset:32352
    ds_write_addtid_b32 v237 offset:32896
    ds_write_addtid_b32 v238 offset:33440
    v_pk_mul_f16 v239, v235, v228 op_sel:[0,0] op_sel_hi:[1,0]
    v_pk_fma_f16 v239, v235, v228, v239 op_sel:[1,1,0] op_sel_hi:[0,1,1] neg_lo:[1,0,0]
    v_pk_mul_f16 v240, v236, v228 op_sel:[0,0] op_sel_hi:[1,0]
    v_pk_fma_f16 v240, v236, v228, v240 op_sel:[1,1,0] op_sel_hi:[0,1,1] neg_lo:[1,0,0]
    v_pk_mul_f16 v241, v237, v228 op_sel:[0,0] op_sel_hi:[1,0]
    v_pk_fma_f16 v241, v237, v228, v241 op_sel:[1,1,0] op_sel_hi:[0,1,1] neg_lo:[1,0,0]
    v_pk_mul_f16 v242, v238, v228 op_sel:[0,0] op_sel_hi:[1,0]
    v_pk_fma_f16 v242, v238, v228, v242 op_sel:[1,1,0] op_sel_hi:[0,1,1] neg_lo:[1,0,0]
    ds_write_addtid_b32 v239 offset:33984
    ds_write_addtid_b32 v240 offset:34528
    ds_write_addtid_b32 v241 offset:35072
    ds_write_addtid_b32 v242 offset:35616
    s_mov_b64 exec, 1
    ds_add_u32 v1, v39 offset:52
    s_mov_b64 exec, -1
    s_waitcnt lgkmcnt(9)
    v_cmp_gt_u32 vcc, 2, v44
    s_cbranch_vccz L_gax
L_ga:
    ds_read_b32 v44, v1 offset:48
    ds_read_b128 v[96:99], v58 offset:13312
    ds_read_b128 v[100:103], v59 offset:36160
    ds_read_b128 v[104:107], v58 offset:13376
    ds_read_b128 v[108:111], v59 offset:36224
    ds_read_b128 v[112:115], v58 offset:13440
    ds_read_b128 v[116:119], v59 offset:36288
    ds_read_b128 v[120:123], v58 offset:13504
    ds_read_b128 v[124:127], v59 offset:36352
    s_add_u32 s75, s75, 1
    s_cmp_ge_u32 s75, 960000
    s_waitcnt lgkmcnt(8)
    s_cbranch_scc1 L_gay
    v_cmp_gt_u32 vcc, 2, v44
    s_cbranch_vccnz L_ga
L_gay:
    s_waitcnt lgkmcnt(0)
L_gax:
    v_mfma_f32_16x16x32_f16 v[40:43], v[96:99], v[100:103], v[40:43]
    v_mfma_f32_16x16x32_f16 v[40:43], v[104:107], v[108:111], v[40:43]
    v_mfma_f32_16x16x32_f16 v[40:43], v[112:115], v[116:119], v[40:43]
    v_mfma_f32_16x16x32_f16 v[40:43], v[120:123], v[124:127], v[40:43]
    s_nop 7
    v_cvt_pk_f16_f32 v44, v40, v41
    v_cvt_pk_f16_f32 v45, v42, v43
    v_cvt_pk_f16_f32 v46, v41, v42
    ds_write_b64 v21, v[44:45]
    ds_write2_b32 v22, v44, v45 offset0:0 offset1:1
    ds_write_b32 v21, v46 offset:1600
    ds_write_b32 v21, v46 offset:4796
    ds_write_b16 v21, v44 offset:1598
    ds_write_b16_d16_hi v21, v45 offset:1604
    ds_write_b16 v21, v44 offset:4794
    ds_write_b16_d16_hi v21, v45 offset:4800
    s_cmp_ge_u32 s4, 2
    s_cbranch_scc1 L_convY
    s_mov_b64 exec, 1
    ds_add_u32 v1, v39 offset:56
    s_mov_b64 exec, -1
    ds_read_b64 v[156:157], v24 offset:448
    ds_read_b64 v[158:159], v24 offset:456
    ds_read_b64 v[152:153], v24 offset:384
    ds_read_b64 v[154:155], v24 offset:392
    ds_read_b64 v[148:149], v24 offset:320
    ds_read_b64 v[150:151], v24 offset:328
    ds_read_b64 v[144:145], v24 offset:256
    ds_read_b64 v[146:147], v24 offset:264
    ds_read_b64 v[140:141], v24 offset:192
    ds_read_b64 v[142:143], v24 offset:200
    ds_read_b64 v[136:137], v24 offset:128
    ds_read_b64 v[138:139], v24 offset:136
    ds_read_b64 v[132:133], v24 offset:64
    ds_read_b64 v[134:135], v24 offset:72
    ds_read_b64 v[128:129], v24 offset:0
    ds_read_b64 v[130:131], v24 offset:8
L_kw1:
    ds_read_b32 v56, v1 offset:56
    ds_read_b64 v[188:189], v24 offset:960
    ds_read_b64 v[190:191], v24 offset:968
    ds_read_b64 v[184:185], v24 offset:896
    ds_read_b64 v[186:187], v24 offset:904
    ds_read_b64 v[180:181], v24 offset:832
    ds_read_b64 v[182:183], v24 offset:840
    ds_read_b64 v[176:177], v24 offset:768
    ds_read_b64 v[178:179], v24 offset:776
    ds_read_b64 v[172:173], v24 offset:704
    ds_read_b64 v[174:175], v24 offset:712
    ds_read_b64 v[168:169], v24 offset:640
    ds_read_b64 v[170:171], v24 offset:648
    s_add_u32 s75, s75, 1
    s_cmp_ge_u32 s75, 960000
    s_waitcnt lgkmcnt(12)
    s_cbranch_scc1 L_kw1x
    v_cmp_gt_u32 vcc, 2, v56
    s_cbranch_vccnz L_kw1
L_kw1x:
    ds_read_b64 v[164:165], v24 offset:576
    ds_read_b64 v[166:167], v24 offset:584
    ds_read_b64 v[160:161], v24 offset:512
    ds_read_b64 v[162:163], v24 offset:520
    ds_read_b64 v[192:193], v24 offset:1024
    ds_read_b64 v[194:195], v24 offset:1032
L_kw2:
    ds_read_b32 v56, v1 offset:60
    ds_read_b64 v[220:221], v28 offset:64
    ds_read_b64 v[222:223], v28 offset:72
    ds_read_b64 v[228:229], v28 offset:192
    ds_read_b64 v[230:231], v28 offset:200
    ds_read_b64 v[236:237], v28 offset:320
    ds_read_b64 v[238:239], v28 offset:328
    ds_read_b64 v[216:217], v28 offset:0
    ds_read_b64 v[218:219], v28 offset:8
    ds_read_b64 v[224:225], v28 offset:128
    ds_read_b64 v[226:227], v28 offset:136
    ds_read_b64 v[232:233], v28 offset:256
    ds_read_b64 v[234:235], v28 offset:264
    s_add_u32 s75, s75, 1
    s_cmp_ge_u32 s75, 960000
    s_waitcnt lgkmcnt(12)
    s_cbranch_scc1 L_kw2x
    v_cmp_gt_u32 vcc, 1, v56
    s_cbranch_vccnz L_kw2
L_kw2x:
    ds_read_b64 v[212:213], v24 offset:1344
    ds_read_b64 v[214:215], v24 offset:1352
    ds_read2_b32 v[240:241], v29 offset0:128 offset1:129
    ds_read2_b32 v[242:243], v29 offset0:130 offset1:131
    s_add_u32 s5, s51, 32768
    buffer_load_dwordx4 v[48:51], v30, s[40:43], s51 offen sc1
    buffer_load_dwordx4 v[52:55], v30, s[40:43], s5 offen sc1
L_x1p3:
    s_add_u32 s68, s68, 1
    s_waitcnt vmcnt(1)
    v_xor_b32 v48, s44, v48
    v_xor_b32 v49, s45, v49
    v_xor_b32 v50, s46, v50
    v_xor_b32 v51, s47, v51
    ds_write_b128 v31, v[48:51] offset:0
    v_or3_b32 v56, v48, v49, v50
    v_or_b32 v56, v56, v51
    s_waitcnt vmcnt(0)
    v_xor_b32 v52, s44, v52
    v_xor_b32 v53, s45, v53
    v_xor_b32 v54, s46, v54
    v_xor_b32 v55, s47, v55
    ds_write_b128 v31, v[52:55] offset:512
    v_or3_b32 v56, v56, v52, v53
    v_or3_b32 v56, v56, v54, v55
    v_and_b32 v56, 0x00070007, v56
    v_cmp_ne_u32 vcc, 0, v56
    s_cbranch_vccz L_x1o4
    s_cmp_ge_u32 s68, 60000
    s_cbranch_scc1 L_x1o4
    s_mov_b64 exec, vcc
    s_add_u32 s5, s51, 32768
    buffer_load_dwordx4 v[48:51], v30, s[40:43], s51 offen sc1
    buffer_load_dwordx4 v[52:55], v30, s[40:43], s5 offen sc1
    s_branch L_x1p3
L_x1o4:
    s_mov_b64 exec, 1
    ds_add_u32 v14, v39 offset:24
    s_mov_b64 exec, -1
    s_setprio 2
    s_mov_b32 s75, 0
L_xw5:
    ds_read_b32 v52, v14 offset:24
    ds_read_b128 v[80:83], v25 offset:1056
    ds_read_b128 v[84:87], v25 offset:1120
    ds_read_b128 v[88:91], v25 offset:1184
    ds_read_b128 v[92:95], v27 offset:1488
    s_add_u32 s75, s75, 1
    s_cmp_ge_u32 s75, 960000
    s_waitcnt lgkmcnt(4)
    s_cbranch_scc1 L_xw5x
    v_cmp_gt_u32 vcc, 4, v52
    s_cbranch_vccnz L_xw5
L_xw5x:
    s_waitcnt lgkmcnt(3)
    v_mfma_f32_16x16x32_f16 v[32:35], v[156:159], v[80:83], 0
    ds_read_b128 v[96:99], v25 offset:1248
    ds_read_b128 v[100:103], v25 offset:1312
    v_mfma_f32_16x16x32_f16 v[36:39], v[188:191], v[80:83], 0
    s_waitcnt lgkmcnt(4)
    ds_read_b128 v[104:107], v25 offset:1376
    v_mfma_f32_16x16x32_f16 v[32:35], v[152:155], v[84:87], v[32:35]
    ds_read_b128 v[108:111], v25 offset:1440
    v_mfma_f32_16x16x32_f16 v[36:39], v[184:187], v[84:87], v[36:39]
    s_waitcnt lgkmcnt(5)
    v_mfma_f32_16x16x32_f16 v[32:35], v[148:151], v[88:91], v[32:35]
    ds_read_b128 v[112:115], v27 offset:1744
    v_mfma_f32_16x16x32_f16 v[36:39], v[180:183], v[88:91], v[36:39]
    s_waitcnt lgkmcnt(5)
    v_mfma_f32_16x16x32_f16 v[56:59], v[92:95], v[196:199], 0
    v_mfma_f32_16x16x32_f16 v[60:63], v[92:95], v[200:203], 0
    s_waitcnt lgkmcnt(4)
    v_mfma_f32_16x16x32_f16 v[32:35], v[144:147], v[96:99], v[32:35]
    v_mfma_f32_16x16x32_f16 v[36:39], v[176:179], v[96:99], v[36:39]
    s_waitcnt lgkmcnt(3)
    ds_read_b128 v[116:119], v25 offset:1504
    v_mfma_f32_16x16x32_f16 v[32:35], v[140:143], v[100:103], v[32:35]
    v_mfma_f32_16x16x32_f16 v[36:39], v[172:175], v[100:103], v[36:39]
    s_waitcnt lgkmcnt(3)
    v_cvt_pk_f16_f32 v72, v59, v63
    v_cvt_pk_f16_f32 v73, v58, v62
    v_mfma_f32_16x16x32_f16 v[32:35], v[136:139], v[104:107], v[32:35]
    ds_read_b128 v[120:123], v25 offset:1568
    v_cvt_pk_f16_f32 v74, v57, v61
    v_mfma_f32_16x16x32_f16 v[36:39], v[168:171], v[104:107], v[36:39]
    s_waitcnt lgkmcnt(3)
    v_cvt_pk_f16_f32 v75, v56, v60
    v_mfma_f32_16x16x32_f16 v[32:35], v[132:135], v[108:111], v[32:35]
    ds_read_b128 v[124:127], v25 offset:1632
    v_mfma_f32_16x16x32_f16 v[36:39], v[164:167], v[108:111], v[36:39]
    s_waitcnt lgkmcnt(3)
    v_mfma_f32_16x16x32_f16 v[64:67], v[112:115], v[196:199], 0
    ds_read_b128 v[80:83], v25 offset:1696
    v_mfma_f32_16x16x32_f16 v[68:71], v[112:115], v[200:203], 0
    ds_read_b128 v[84:87], v27 offset:2000
    v_mfma_f32_16x16x32_f16 v[40:43], v[72:75], v[220:223], 0
    v_mfma_f32_16x16x32_f16 v[44:47], v[72:75], v[228:231], 0
    v_mfma_f32_16x16x32_f16 v[48:51], v[72:75], v[236:239], 0
    s_waitcnt lgkmcnt(4)
    v_mfma_f32_16x16x32_f16 v[32:35], v[128:131], v[116:119], v[32:35]
    v_mfma_f32_16x16x32_f16 v[36:39], v[160:163], v[116:119], v[36:39]
    v_mfma_f32_16x16x32_f16 v[40:43], v[192:195], v[116:119], v[40:43]
    s_waitcnt lgkmcnt(3)
    ds_read_b128 v[88:91], v25 offset:1760
    v_cvt_pk_f16_f32 v76, v67, v71
    v_mfma_f32_16x16x32_f16 v[36:39], v[156:159], v[120:123], v[36:39]
    v_cvt_pk_f16_f32 v77, v66, v70
    v_cvt_pk_f16_f32 v78, v65, v69
    v_mfma_f32_16x16x32_f16 v[40:43], v[188:191], v[120:123], v[40:43]
    s_waitcnt lgkmcnt(3)
    ds_read_b128 v[92:95], v25 offset:1824
    v_cvt_pk_f16_f32 v79, v64, v68
    v_mfma_f32_16x16x32_f16 v[36:39], v[152:155], v[124:127], v[36:39]
    v_cvt_pk_f16_f32 v32, v32, v33
    v_cvt_pk_f16_f32 v33, v34, v35
    v_mfma_f32_16x16x32_f16 v[40:43], v[184:187], v[124:127], v[40:43]
    s_waitcnt lgkmcnt(3)
    ds_read_b128 v[96:99], v25 offset:1888
    v_mfma_f32_16x16x32_f16 v[36:39], v[148:151], v[80:83], v[36:39]
    s_waitcnt lgkmcnt(3)
    v_mfma_f32_16x16x32_f16 v[56:59], v[84:87], v[196:199], 0
    ds_read_b128 v[100:103], v25 offset:1952
    v_mfma_f32_16x16x32_f16 v[60:63], v[84:87], v[200:203], 0
    ds_read_b128 v[104:107], v27 offset:2256
    v_mfma_f32_16x16x32_f16 v[40:43], v[76:79], v[216:219], v[40:43]
    v_mfma_f32_16x16x32_f16 v[44:47], v[76:79], v[224:227], v[44:47]
    v_mfma_f32_16x16x32_f16 v[48:51], v[76:79], v[232:235], v[48:51]
    v_mfma_f32_16x16x32_f16 v[40:43], v[180:183], v[80:83], v[40:43]
    s_waitcnt lgkmcnt(4)
    v_mfma_f32_16x16x32_f16 v[36:39], v[144:147], v[88:91], v[36:39]
    ds_read_b128 v[108:111], v25 offset:2016
    v_cvt_pk_f16_f32 v72, v59, v63
    v_mfma_f32_16x16x32_f16 v[40:43], v[176:179], v[88:91], v[40:43]
    s_waitcnt lgkmcnt(4)
    v_cvt_pk_f16_f32 v73, v58, v62
    v_cvt_pk_f16_f32 v74, v57, v61
    v_mfma_f32_16x16x32_f16 v[36:39], v[140:143], v[92:95], v[36:39]
    v_cvt_pk_f16_f32 v75, v56, v60
    v_mfma_f32_16x16x32_f16 v[40:43], v[172:175], v[92:95], v[40:43]
    s_waitcnt lgkmcnt(3)
    ds_read_b128 v[112:115], v25 offset:2080
    v_mfma_f32_16x16x32_f16 v[36:39], v[136:139], v[96:99], v[36:39]
    v_mfma_f32_16x16x32_f16 v[40:43], v[168:171], v[96:99], v[40:43]
    s_waitcnt lgkmcnt(3)
    ds_read_b128 v[116:119], v25 offset:2144
    v_mfma_f32_16x16x32_f16 v[36:39], v[132:135], v[100:103], v[36:39]
    s_waitcnt lgkmcnt(3)
    v_mfma_f32_16x16x32_f16 v[64:67], v[104:107], v[196:199], 0
    ds_read_b128 v[120:123], v25 offset:1504
    v_mfma_f32_16x16x32_f16 v[68:71], v[104:107], v[200:203], 0
    v_mfma_f32_16x16x32_f16 v[44:47], v[72:75], v[220:223], v[44:47]
    ds_read_b128 v[124:127], v25 offset:1488
    v_mfma_f32_16x16x32_f16 v[48:51], v[72:75], v[228:231], v[48:51]
    v_mfma_f32_16x16x32_f16 v[40:43], v[164:167], v[100:103], v[40:43]
    s_waitcnt lgkmcnt(4)
    v_mfma_f32_16x16x32_f16 v[36:39], v[128:131], v[108:111], v[36:39]
    ds_read_b128 v[84:87], v25 offset:2208
    v_mfma_f32_16x16x32_f16 v[40:43], v[160:163], v[108:111], v[40:43]
    v_cvt_pk_f16_f32 v76, v67, v71
    v_cvt_pk_f16_f32 v77, v66, v70
    v_mfma_f32_16x16x32_f16 v[44:47], v[192:195], v[108:111], v[44:47]
    s_waitcnt lgkmcnt(4)
    ds_read_b128 v[80:83], v25 offset:2272
    v_cvt_pk_f16_f32 v78, v65, v69
    v_mfma_f32_16x16x32_f16 v[40:43], v[156:159], v[112:115], v[40:43]
    v_cvt_pk_f16_f32 v79, v64, v68
    v_mfma_f32_16x16x32_f16 v[44:47], v[188:191], v[112:115], v[44:47]
    s_waitcnt lgkmcnt(4)
    ds_read_b128 v[88:91], v25 offset:2336
    v_mfma_f32_16x16x32_f16 v[40:43], v[152:155], v[116:119], v[40:43]
    v_mfma_f32_16x16x32_f16 v[44:47], v[184:187], v[116:119], v[44:47]
    s_waitcnt lgkmcnt(4)
    ds_read_b128 v[92:95], v25 offset:2400
    v_mfma_f32_16x16x32_f16 v[56:59], v[120:123], v[208:211], 0
    v_mfma_f32_16x16x32_f16 v[48:51], v[212:215], v[120:123], v[48:51]
    s_waitcnt lgkmcnt(4)
    ds_read_b128 v[96:99], v27 offset:2512
    v_mfma_f32_16x16x32_f16 v[60:63], v[124:127], v[204:207], 0
    v_mfma_f32_16x16x32_f16 v[44:47], v[76:79], v[216:219], v[44:47]
    v_mfma_f32_16x16x32_f16 v[48:51], v[76:79], v[224:227], v[48:51]
    s_waitcnt lgkmcnt(4)
    ds_read_b128 v[104:107], v25 offset:2464
    v_mfma_f32_16x16x32_f16 v[40:43], v[148:151], v[84:87], v[40:43]
    v_mfma_f32_16x16x32_f16 v[44:47], v[180:183], v[84:87], v[44:47]
    s_waitcnt lgkmcnt(4)
    ds_read_b128 v[100:103], v25 offset:2528
    v_cvt_pk_f16_f32 v72, v59, v63
    v_mfma_f32_16x16x32_f16 v[40:43], v[144:147], v[80:83], v[40:43]
    v_cvt_pk_f16_f32 v73, v58, v62
    v_cvt_pk_f16_f32 v74, v57, v61
    v_mfma_f32_16x16x32_f16 v[44:47], v[176:179], v[80:83], v[44:47]
    s_waitcnt lgkmcnt(4)
    ds_read_b32 v52, v12 offset:16
    v_cvt_pk_f16_f32 v75, v56, v60
    v_mfma_f32_16x16x32_f16 v[40:43], v[140:143], v[88:91], v[40:43]
    ds_read_b64 v[8:9], v5 offset:0
    ds_read_b128 v[108:111], v25 offset:2592
    v_mfma_f32_16x16x32_f16 v[44:47], v[172:175], v[88:91], v[44:47]
    s_waitcnt lgkmcnt(6)
    ds_read_b64 v[10:11], v5 offset:512
    v_mfma_f32_16x16x32_f16 v[40:43], v[136:139], v[92:95], v[40:43]
    ds_read_b64 v[18:19], v5 offset:1024
    ds_read_b128 v[112:115], v25 offset:2656
    v_mfma_f32_16x16x32_f16 v[44:47], v[168:171], v[92:95], v[44:47]
    s_waitcnt lgkmcnt(8)
    ds_read_b64 v[20:21], v5 offset:1536
    ds_read_b128 v[116:119], v27 offset:2768
    v_mfma_f32_16x16x32_f16 v[64:67], v[96:99], v[196:199], 0
    ds_read_b64 v[22:23], v5 offset:2048
    v_mfma_f32_16x16x32_f16 v[68:71], v[96:99], v[200:203], 0
    v_mfma_f32_16x16x32_f16 v[48:51], v[72:75], v[240:243], v[48:51]
    s_waitcnt lgkmcnt(10)
    v_mfma_f32_16x16x32_f16 v[40:43], v[132:135], v[104:107], v[40:43]
    ds_read_b128 v[120:123], v25 offset:2720
    v_mfma_f32_16x16x32_f16 v[44:47], v[164:167], v[104:107], v[44:47]
    s_waitcnt lgkmcnt(10)
    s_waitcnt lgkmcnt(1)
    v_cmp_ne_u32 vcc, 1, v52
    s_cbranch_vccnz L_g6
L_g6r:
    v_mfma_f32_16x16x32_f16 v[40:43], v[128:131], v[100:103], v[40:43]
    ds_read_b128 v[124:127], v25 offset:2784
    v_cvt_pk_f16_f32 v76, v67, v71
    v_mfma_f32_16x16x32_f16 v[44:47], v[160:163], v[100:103], v[44:47]
    v_cvt_pk_f16_f32 v77, v66, v70
    v_cvt_pk_f16_f32 v78, v65, v69
    v_mfma_f32_16x16x32_f16 v[48:51], v[192:195], v[100:103], v[48:51]
    ds_read_b128 v[84:87], v25 offset:2848
    v_cvt_pk_f16_f32 v79, v64, v68
    v_mfma_f32_16x16x32_f16 v[44:47], v[156:159], v[108:111], v[44:47]
    v_pk_mul_f16 v32, v32, v8
    v_pk_mul_f16 v33, v33, v9
    v_mfma_f32_16x16x32_f16 v[48:51], v[188:191], v[108:111], v[48:51]
    ds_read_b128 v[80:83], v25 offset:2912
    v_add_u32 v32, 0x00040004, v32
    v_mfma_f32_16x16x32_f16 v[44:47], v[152:155], v[112:115], v[44:47]
    v_add_u32 v33, 0x00040004, v33
    v_and_or_b32 v32, v32, v13, v17
    v_mfma_f32_16x16x32_f16 v[56:59], v[116:119], v[196:199], 0
    v_and_or_b32 v33, v33, v13, v2
    v_cvt_pk_f16_f32 v36, v36, v37
    v_mfma_f32_16x16x32_f16 v[60:63], v[116:119], v[200:203], 0
    ds_read_b128 v[88:91], v25 offset:2976
    v_cvt_pk_f16_f32 v37, v38, v39
    v_mfma_f32_16x16x32_f16 v[48:51], v[76:79], v[220:223], v[48:51]
    v_pk_mul_f16 v36, v36, v10
    v_pk_mul_f16 v37, v37, v11
    v_mfma_f32_16x16x32_f16 v[48:51], v[184:187], v[112:115], v[48:51]
    s_waitcnt lgkmcnt(4)
    ds_read_b128 v[92:95], v25 offset:3040
    v_cvt_pk_f16_f32 v72, v59, v63
    v_mfma_f32_16x16x32_f16 v[44:47], v[148:151], v[120:123], v[44:47]
    v_cvt_pk_f16_f32 v73, v58, v62
    v_cvt_pk_f16_f32 v74, v57, v61
    v_mfma_f32_16x16x32_f16 v[48:51], v[180:183], v[120:123], v[48:51]
    s_waitcnt lgkmcnt(4)
    ds_read_b128 v[96:99], v25 offset:3104
    v_cvt_pk_f16_f32 v75, v56, v60
    v_mfma_f32_16x16x32_f16 v[44:47], v[144:147], v[124:127], v[44:47]
    ds_read_b128 v[104:107], v25 offset:3168
    v_add_u32 v36, 0x00040004, v36
    v_mfma_f32_16x16x32_f16 v[48:51], v[176:179], v[124:127], v[48:51]
    s_waitcnt lgkmcnt(5)
    ds_read_b128 v[100:103], v25 offset:3232
    v_add_u32 v37, 0x00040004, v37
    v_mfma_f32_16x16x32_f16 v[44:47], v[140:143], v[84:87], v[44:47]
    ds_read_b128 v[108:111], v25 offset:3296
    v_and_or_b32 v34, v36, v13, v17
    v_mfma_f32_16x16x32_f16 v[48:51], v[172:175], v[84:87], v[48:51]
    s_waitcnt lgkmcnt(6)
    ds_read_b128 v[116:119], v25 offset:3360
    v_and_or_b32 v35, v37, v13, v2
    v_mfma_f32_16x16x32_f16 v[44:47], v[136:139], v[80:83], v[44:47]
    s_xor_b32 s5, s58, 0
    ds_read_b128 v[112:115], v25 offset:3424
    v_permlane16_swap_b32 v32, v34
    v_mfma_f32_16x16x32_f16 v[48:51], v[72:75], v[216:219], v[48:51]
    ds_read_b128 v[120:123], v25 offset:3488
    v_permlane16_swap_b32 v33, v35
    v_mfma_f32_16x16x32_f16 v[48:51], v[168:171], v[80:83], v[48:51]
    s_waitcnt lgkmcnt(8)
    buffer_store_dwordx4 v[32:35], v7, s[40:43], s5 offen
    v_mfma_f32_16x16x32_f16 v[44:47], v[132:135], v[88:91], v[44:47]
    ds_add_u32 v4, v6 offset:96
    v_cvt_pk_f16_f32 v40, v40, v41
    v_mfma_f32_16x16x32_f16 v[48:51], v[164:167], v[88:91], v[48:51]
    s_waitcnt lgkmcnt(8)
    ds_read_b128 v[124:127], v25 offset:3552
    v_cvt_pk_f16_f32 v41, v42, v43
    v_mfma_f32_16x16x32_f16 v[44:47], v[128:131], v[92:95], v[44:47]
    v_pk_mul_f16 v40, v40, v18
    v_pk_mul_f16 v41, v41, v19
    v_mfma_f32_16x16x32_f16 v[48:51], v[160:163], v[92:95], v[48:51]
    s_waitcnt lgkmcnt(8)
    v_add_u32 v40, 0x00040004, v40
    v_add_u32 v41, 0x00040004, v41
    v_mfma_f32_16x16x32_f16 v[48:51], v[156:159], v[96:99], v[48:51]
    s_waitcnt lgkmcnt(7)
    v_and_or_b32 v40, v40, v13, v17
    v_and_or_b32 v41, v41, v13, v2
    v_mfma_f32_16x16x32_f16 v[48:51], v[152:155], v[104:107], v[48:51]
    s_waitcnt lgkmcnt(6)
    v_cvt_pk_f16_f32 v44, v44, v45
    v_cvt_pk_f16_f32 v45, v46, v47
    v_mfma_f32_16x16x32_f16 v[48:51], v[148:151], v[100:103], v[48:51]
    s_waitcnt lgkmcnt(5)
    v_pk_mul_f16 v44, v44, v20
    v_pk_mul_f16 v45, v45, v21
    v_mfma_f32_16x16x32_f16 v[48:51], v[144:147], v[108:111], v[48:51]
    s_waitcnt lgkmcnt(4)
    v_add_u32 v44, 0x00040004, v44
    v_add_u32 v45, 0x00040004, v45
    v_mfma_f32_16x16x32_f16 v[48:51], v[140:143], v[116:119], v[48:51]
    s_waitcnt lgkmcnt(3)
    v_and_or_b32 v42, v44, v13, v17
    v_and_or_b32 v43, v45, v13, v2
    v_mfma_f32_16x16x32_f16 v[48:51], v[136:139], v[112:115], v[48:51]
    s_waitcnt lgkmcnt(2)
    v_mfma_f32_16x16x32_f16 v[48:51], v[132:135], v[120:123], v[48:51]
    s_waitcnt lgkmcnt(0)
    v_mfma_f32_16x16x32_f16 v[48:51], v[128:131], v[124:127], v[48:51]
    s_xor_b32 s5, s58, 65536
    v_permlane16_swap_b32 v40, v42
    v_permlane16_swap_b32 v41, v43
    buffer_store_dwordx4 v[40:43], v7, s[40:43], s5 offen
    ds_add_u32 v4, v6 offset:104
    s_nop 2
    v_cvt_pk_f16_f32 v48, v48, v49
    v_cvt_pk_f16_f32 v49, v50, v51
    v_pk_mul_f16 v48, v48, v22
    v_pk_mul_f16 v49, v49, v23
    v_add_u32 v48, 0x00040004, v48
    v_add_u32 v49, 0x00040004, v49
    v_and_or_b32 v48, v48, v13, v17
    v_and_or_b32 v49, v49, v13, v2
    s_xor_b32 s5, s58, 131072
    v_permlane16_swap_b32 v48, v50
    v_permlane16_swap_b32 v49, v51
    buffer_store_dwordx4 v[48:51], v26, s[40:43], s5 offen
    ds_add_u32 v4, v6 offset:112
    s_cmp_eq_u32 s61, 0
    s_cbranch_scc1 L_last
    v_xor_b32 v26, 0x20000000, v26
    v_xor_b32 v7, 0x20000000, v7
    s_xor_b32 s5, s58, 0
    buffer_store_dwordx4 v[32:35], v7, s[40:43], s5 offen sc1
    s_xor_b32 s5, s58, 65536
    buffer_store_dwordx4 v[40:43], v7, s[40:43], s5 offen sc1
    s_xor_b32 s5, s58, 131072
    buffer_store_dwordx4 v[48:51], v26, s[40:43], s5 offen sc1
    s_endpgm
L_g6:
    ds_read_b32 v52, v12 offset:16
    ds_read_b64 v[8:9], v5 offset:0
    ds_read_b64 v[10:11], v5 offset:512
    ds_read_b64 v[18:19], v5 offset:1024
    ds_read_b64 v[20:21], v5 offset:1536
    ds_read_b64 v[22:23], v5 offset:2048
    s_add_u32 s75, s75, 1
    s_cmp_ge_u32 s75, 1920000
    s_waitcnt lgkmcnt(0)
    s_cbranch_scc1 L_g6r
    v_cmp_eq_u32 vcc, 0, v52
    s_cbranch_vccnz L_g6
    v_cmp_eq_u32 vcc, 1, v52
    s_cbranch_vccnz L_g6r
    s_mov_b32 s61, 1
    v_xor_b32 v26, 0x20000000, v26
    v_xor_b32 v7, 0x20000000, v7
    s_branch L_g6r
.p2align 6
L_stubY:
    s_branch L_stubYr
L_convY:
    v_readlane_b32 s6, v45, 63
    s_nop 1
    v_mov_b32 v47, s6
    s_mov_b64 exec, 0xfff
    ds_write_b16_d16_hi v23, v47 offset:1056
    s_mov_b64 exec, 1
    ds_add_u32 v1, v39 offset:56
    s_mov_b64 exec, -1
    ds_read_b64 v[192:193], v24 offset:1024
    ds_read_b64 v[194:195], v24 offset:1032
    ds_read_b64 v[188:189], v24 offset:960
    ds_read_b64 v[190:191], v24 offset:968
    ds_read_b64 v[184:185], v24 offset:896
    ds_read_b64 v[186:187], v24 offset:904
    ds_read_b64 v[180:181], v24 offset:832
    ds_read_b64 v[182:183], v24 offset:840
    ds_read_b64 v[176:177], v24 offset:768
    ds_read_b64 v[178:179], v24 offset:776
    ds_read_b64 v[172:173], v24 offset:704
    ds_read_b64 v[174:175], v24 offset:712
    ds_read_b64 v[168:169], v24 offset:640
    ds_read_b64 v[170:171], v24 offset:648
    ds_read_b64 v[164:165], v24 offset:576
    ds_read_b64 v[166:167], v24 offset:584
L_kw7:
    ds_read_b32 v56, v1 offset:56
    ds_read_b64 v[160:161], v24 offset:512
    ds_read_b64 v[162:163], v24 offset:520
    ds_read_b64 v[156:157], v24 offset:448
    ds_read_b64 v[158:159], v24 offset:456
    ds_read_b64 v[152:153], v24 offset:384
    ds_read_b64 v[154:155], v24 offset:392
    ds_read_b64 v[148:149], v24 offset:320
    ds_read_b64 v[150:151], v24 offset:328
    ds_read_b64 v[144:145], v24 offset:256
    ds_read_b64 v[146:147], v24 offset:264
    ds_read_b64 v[140:141], v24 offset:192
    ds_read_b64 v[142:143], v24 offset:200
    s_add_u32 s75, s75, 1
    s_cmp_ge_u32 s75, 960000
    s_waitcnt lgkmcnt(12)
    s_cbranch_scc1 L_kw7x
    v_cmp_gt_u32 vcc, 2, v56
    s_cbranch_vccnz L_kw7
L_kw7x:
    ds_read_b64 v[136:137], v24 offset:128
    ds_read_b64 v[138:139], v24 offset:136
    ds_read_b64 v[132:133], v24 offset:64
    ds_read_b64 v[134:135], v24 offset:72
    ds_read_b64 v[128:129], v24 offset:0
    ds_read_b64 v[130:131], v24 offset:8
L_kw8:
    ds_read_b32 v56, v1 offset:60
    ds_read2_b32 v[244:245], v29 offset0:144 offset1:145
    ds_read2_b32 v[246:247], v29 offset0:146 offset1:147
    ds_read2_b32 v[248:249], v29 offset0:160 offset1:161
    ds_read2_b32 v[250:251], v29 offset0:162 offset1:163
    ds_read2_b32 v[252:253], v29 offset0:176 offset1:177
    ds_read2_b32 v[254:255], v29 offset0:178 offset1:179
    ds_read_b64 v[236:237], v28 offset:320
    ds_read_b64 v[238:239], v28 offset:328
    ds_read_b64 v[212:213], v24 offset:1344
    ds_read_b64 v[214:215], v24 offset:1352
    ds_read_b64 v[232:233], v28 offset:256
    ds_read_b64 v[234:235], v28 offset:264
    s_add_u32 s75, s75, 1
    s_cmp_ge_u32 s75, 960000
    s_waitcnt lgkmcnt(12)
    s_cbranch_scc1 L_kw8x
    v_cmp_gt_u32 vcc, 1, v56
    s_cbranch_vccnz L_kw8
L_kw8x:
    ds_read2_b32 v[240:241], v29 offset0:128 offset1:129
    ds_read2_b32 v[242:243], v29 offset0:130 offset1:131
    ds_read_b64 v[228:229], v28 offset:192
    ds_read_b64 v[230:231], v28 offset:200
    ds_read_b64 v[224:225], v28 offset:128
    ds_read_b64 v[226:227], v28 offset:136
    ds_read_b64 v[220:221], v28 offset:64
    ds_read_b64 v[222:223], v28 offset:72
    ds_read_b64 v[216:217], v28 offset:0
    ds_read_b64 v[218:219], v28 offset:8
    s_add_u32 s5, s51, 32768
    buffer_load_dwordx4 v[48:51], v30, s[40:43], s51 offen sc1
    buffer_load_dwordx4 v[52:55], v30, s[40:43], s5 offen sc1
L_x1p9:
    s_add_u32 s68, s68, 1
    s_waitcnt vmcnt(1)
    v_xor_b32 v48, s44, v48
    v_xor_b32 v49, s45, v49
    v_xor_b32 v50, s46, v50
    v_xor_b32 v51, s47, v51
    ds_write_b128 v31, v[48:51] offset:0
    v_or3_b32 v56, v48, v49, v50
    v_or_b32 v56, v56, v51
    s_waitcnt vmcnt(0)
    v_xor_b32 v52, s44, v52
    v_xor_b32 v53, s45, v53
    v_xor_b32 v54, s46, v54
    v_xor_b32 v55, s47, v55
    ds_write_b128 v31, v[52:55] offset:512
    v_or3_b32 v56, v56, v52, v53
    v_or3_b32 v56, v56, v54, v55
    v_and_b32 v56, 0x00070007, v56
    v_cmp_ne_u32 vcc, 0, v56
    s_cbranch_vccz L_x1o10
    s_cmp_ge_u32 s68, 60000
    s_cbranch_scc1 L_x1o10
    s_mov_b64 exec, vcc
    s_add_u32 s5, s51, 32768
    buffer_load_dwordx4 v[48:51], v30, s[40:43], s51 offen sc1
    buffer_load_dwordx4 v[52:55], v30, s[40:43], s5 offen sc1
    s_branch L_x1p9
L_x1o10:
    s_mov_b64 exec, 1
    ds_add_u32 v14, v39 offset:24
    s_mov_b64 exec, -1
    s_setprio 2
    s_mov_b32 s75, 0
L_xw11:
    ds_read_b32 v52, v14 offset:24
    ds_read_b128 v[80:83], v25 offset:1504
    ds_read_b128 v[84:87], v25 offset:1488
    ds_read_b128 v[88:91], v25 offset:3040
    ds_read_b128 v[92:95], v25 offset:3104
    s_add_u32 s75, s75, 1
    s_cmp_ge_u32 s75, 960000
    s_waitcnt lgkmcnt(4)
    s_cbranch_scc1 L_xw11x
    v_cmp_gt_u32 vcc, 4, v52
    s_cbranch_vccnz L_xw11
L_xw11x:
    ds_read_b128 v[96:99], v25 offset:3168
    ds_read_b128 v[100:103], v25 offset:3232
    ds_read_b128 v[104:107], v25 offset:3296
    ds_read_b128 v[108:111], v27 offset:2000
    s_waitcnt lgkmcnt(7)
    v_mfma_f32_16x16x32_f16 v[56:59], v[80:83], v[208:211], 0
    s_waitcnt lgkmcnt(6)
    ds_read_b128 v[112:115], v25 offset:3360
    v_mfma_f32_16x16x32_f16 v[60:63], v[84:87], v[204:207], 0
    s_waitcnt lgkmcnt(6)
    ds_read_b128 v[116:119], v25 offset:3424
    v_mfma_f32_16x16x32_f16 v[32:35], v[192:195], v[88:91], 0
    s_waitcnt lgkmcnt(6)
    ds_read_b128 v[120:123], v25 offset:3488
    v_mfma_f32_16x16x32_f16 v[32:35], v[188:191], v[92:95], v[32:35]
    s_waitcnt lgkmcnt(6)
    ds_read_b128 v[124:127], v27 offset:2256
    v_cvt_pk_f16_f32 v72, v59, v63
    v_mfma_f32_16x16x32_f16 v[32:35], v[184:187], v[96:99], v[32:35]
    s_waitcnt lgkmcnt(6)
    v_cvt_pk_f16_f32 v73, v58, v62
    v_cvt_pk_f16_f32 v74, v57, v61
    v_mfma_f32_16x16x32_f16 v[32:35], v[180:183], v[100:103], v[32:35]
    s_waitcnt lgkmcnt(5)
    v_cvt_pk_f16_f32 v75, v56, v60
    v_mfma_f32_16x16x32_f16 v[32:35], v[176:179], v[104:107], v[32:35]
    s_waitcnt lgkmcnt(4)
    ds_read_b128 v[80:83], v25 offset:3552
    v_mfma_f32_16x16x32_f16 v[64:67], v[108:111], v[196:199], 0
    v_mfma_f32_16x16x32_f16 v[68:71], v[108:111], v[200:203], 0
    ds_read_b128 v[84:87], v25 offset:3616
    v_mfma_f32_16x16x32_f16 v[32:35], v[72:75], v[244:247], v[32:35]
    ds_read_b128 v[88:91], v25 offset:2016
    v_mfma_f32_16x16x32_f16 v[36:39], v[72:75], v[248:251], 0
    v_mfma_f32_16x16x32_f16 v[40:43], v[72:75], v[252:255], 0
    s_waitcnt lgkmcnt(6)
    ds_read_b128 v[92:95], v25 offset:2000
    v_mfma_f32_16x16x32_f16 v[32:35], v[172:175], v[112:115], v[32:35]
    s_waitcnt lgkmcnt(6)
    v_cvt_pk_f16_f32 v76, v67, v71
    v_cvt_pk_f16_f32 v77, v66, v70
    v_mfma_f32_16x16x32_f16 v[32:35], v[168:171], v[116:119], v[32:35]
    s_waitcnt lgkmcnt(5)
    v_cvt_pk_f16_f32 v78, v65, v69
    v_cvt_pk_f16_f32 v79, v64, v68
    v_mfma_f32_16x16x32_f16 v[32:35], v[164:167], v[120:123], v[32:35]
    s_waitcnt lgkmcnt(4)
    ds_read_b128 v[96:99], v25 offset:3680
    v_mfma_f32_16x16x32_f16 v[56:59], v[124:127], v[196:199], 0
    v_mfma_f32_16x16x32_f16 v[60:63], v[124:127], v[200:203], 0
    ds_read_b128 v[100:103], v27 offset:2512
    v_mfma_f32_16x16x32_f16 v[32:35], v[76:79], v[236:239], v[32:35]
    s_waitcnt lgkmcnt(5)
    v_mfma_f32_16x16x32_f16 v[32:35], v[160:163], v[80:83], v[32:35]
    v_mfma_f32_16x16x32_f16 v[36:39], v[192:195], v[80:83], v[36:39]
    s_waitcnt lgkmcnt(4)
    v_mfma_f32_16x16x32_f16 v[32:35], v[156:159], v[84:87], v[32:35]
    s_waitcnt lgkmcnt(3)
    v_cvt_pk_f16_f32 v72, v59, v63
    v_cvt_pk_f16_f32 v73, v58, v62
    v_mfma_f32_16x16x32_f16 v[64:67], v[88:91], v[208:211], 0
    ds_read_b128 v[104:107], v25 offset:3744
    v_cvt_pk_f16_f32 v74, v57, v61
    v_mfma_f32_16x16x32_f16 v[32:35], v[212:215], v[88:91], v[32:35]
    s_waitcnt lgkmcnt(3)
    v_cvt_pk_f16_f32 v75, v56, v60
    v_mfma_f32_16x16x32_f16 v[68:71], v[92:95], v[204:207], 0
    ds_read_b128 v[108:111], v25 offset:3808
    v_mfma_f32_16x16x32_f16 v[32:35], v[72:75], v[232:235], v[32:35]
    v_mfma_f32_16x16x32_f16 v[36:39], v[188:191], v[84:87], v[36:39]
    s_waitcnt lgkmcnt(3)
    ds_read_b128 v[112:115], v27 offset:2768
    v_mfma_f32_16x16x32_f16 v[32:35], v[152:155], v[96:99], v[32:35]
    v_mfma_f32_16x16x32_f16 v[36:39], v[184:187], v[96:99], v[36:39]
    s_waitcnt lgkmcnt(3)
    v_cvt_pk_f16_f32 v76, v67, v71
    v_cvt_pk_f16_f32 v77, v66, v70
    v_mfma_f32_16x16x32_f16 v[56:59], v[100:103], v[196:199], 0
    v_cvt_pk_f16_f32 v78, v65, v69
    v_cvt_pk_f16_f32 v79, v64, v68
    v_mfma_f32_16x16x32_f16 v[60:63], v[100:103], v[200:203], 0
    ds_read_b128 v[116:119], v25 offset:3872
    v_mfma_f32_16x16x32_f16 v[32:35], v[76:79], v[240:243], v[32:35]
    v_mfma_f32_16x16x32_f16 v[36:39], v[76:79], v[244:247], v[36:39]
    ds_read_b128 v[120:123], v25 offset:3936
    v_mfma_f32_16x16x32_f16 v[40:43], v[76:79], v[248:251], v[40:43]
    s_waitcnt lgkmcnt(4)
    ds_read_b128 v[124:127], v27 offset:3024
    v_mfma_f32_16x16x32_f16 v[32:35], v[148:151], v[104:107], v[32:35]
    v_cvt_pk_f16_f32 v72, v59, v63
    v_cvt_pk_f16_f32 v73, v58, v62
    v_mfma_f32_16x16x32_f16 v[36:39], v[180:183], v[104:107], v[36:39]
    s_waitcnt lgkmcnt(4)
    v_cvt_pk_f16_f32 v74, v57, v61
    v_cvt_pk_f16_f32 v75, v56, v60
    v_mfma_f32_16x16x32_f16 v[32:35], v[144:147], v[108:111], v[32:35]
    v_mfma_f32_16x16x32_f16 v[36:39], v[176:179], v[108:111], v[36:39]
    s_waitcnt lgkmcnt(3)
    v_mfma_f32_16x16x32_f16 v[64:67], v[112:115], v[196:199], 0
    ds_read_b128 v[80:83], v25 offset:4000
    v_mfma_f32_16x16x32_f16 v[68:71], v[112:115], v[200:203], 0
    v_mfma_f32_16x16x32_f16 v[32:35], v[72:75], v[228:231], v[32:35]
    ds_read_b128 v[88:91], v27 offset:3280
    v_mfma_f32_16x16x32_f16 v[36:39], v[72:75], v[236:239], v[36:39]
    s_waitcnt lgkmcnt(4)
    v_mfma_f32_16x16x32_f16 v[32:35], v[140:143], v[116:119], v[32:35]
    v_mfma_f32_16x16x32_f16 v[36:39], v[172:175], v[116:119], v[36:39]
    s_waitcnt lgkmcnt(3)
    v_mfma_f32_16x16x32_f16 v[32:35], v[136:139], v[120:123], v[32:35]
    s_waitcnt lgkmcnt(2)
    v_cvt_pk_f16_f32 v76, v67, v71
    v_cvt_pk_f16_f32 v77, v66, v70
    v_mfma_f32_16x16x32_f16 v[56:59], v[124:127], v[196:199], 0
    v_cvt_pk_f16_f32 v78, v65, v69
    v_cvt_pk_f16_f32 v79, v64, v68
    v_mfma_f32_16x16x32_f16 v[60:63], v[124:127], v[200:203], 0
    ds_read_b128 v[92:95], v25 offset:4064
    v_mfma_f32_16x16x32_f16 v[32:35], v[76:79], v[224:227], v[32:35]
    v_mfma_f32_16x16x32_f16 v[36:39], v[76:79], v[232:235], v[36:39]
    ds_read_b128 v[84:87], v25 offset:4128
    v_mfma_f32_16x16x32_f16 v[36:39], v[168:171], v[120:123], v[36:39]
    s_waitcnt lgkmcnt(3)
    ds_read_b128 v[96:99], v25 offset:2528
    v_mfma_f32_16x16x32_f16 v[32:35], v[132:135], v[80:83], v[32:35]
    v_cvt_pk_f16_f32 v72, v59, v63
    v_cvt_pk_f16_f32 v73, v58, v62
    v_mfma_f32_16x16x32_f16 v[36:39], v[164:167], v[80:83], v[36:39]
    s_waitcnt lgkmcnt(3)
    ds_read_b128 v[100:103], v25 offset:2512
    v_cvt_pk_f16_f32 v74, v57, v61
    v_mfma_f32_16x16x32_f16 v[64:67], v[88:91], v[196:199], 0
    v_cvt_pk_f16_f32 v75, v56, v60
    v_mfma_f32_16x16x32_f16 v[68:71], v[88:91], v[200:203], 0
    s_nop 0
    v_mfma_f32_16x16x32_f16 v[32:35], v[72:75], v[220:223], v[32:35]
    v_mfma_f32_16x16x32_f16 v[36:39], v[72:75], v[228:231], v[36:39]
    v_mfma_f32_16x16x32_f16 v[40:43], v[72:75], v[236:239], v[40:43]
    s_waitcnt lgkmcnt(3)
    ds_read_b128 v[104:107], v25 offset:4192
    v_mfma_f32_16x16x32_f16 v[32:35], v[128:131], v[92:95], v[32:35]
    v_mfma_f32_16x16x32_f16 v[36:39], v[160:163], v[92:95], v[36:39]
    ds_read_b128 v[108:111], v27 offset:3536
    v_cvt_pk_f16_f32 v76, v67, v71
    v_mfma_f32_16x16x32_f16 v[40:43], v[192:195], v[92:95], v[40:43]
    s_waitcnt lgkmcnt(4)
    v_cvt_pk_f16_f32 v77, v66, v70
    v_cvt_pk_f16_f32 v78, v65, v69
    v_mfma_f32_16x16x32_f16 v[36:39], v[156:159], v[84:87], v[36:39]
    s_waitcnt lgkmcnt(3)
    v_cvt_pk_f16_f32 v79, v64, v68
    v_mfma_f32_16x16x32_f16 v[56:59], v[96:99], v[208:211], 0
    v_mfma_f32_16x16x32_f16 v[36:39], v[212:215], v[96:99], v[36:39]
    s_waitcnt lgkmcnt(2)
    ds_read_b128 v[112:115], v25 offset:4256
    v_mfma_f32_16x16x32_f16 v[60:63], v[100:103], v[204:207], 0
    v_mfma_f32_16x16x32_f16 v[32:35], v[76:79], v[216:219], v[32:35]
    ds_read_b128 v[116:119], v25 offset:4320
    v_mfma_f32_16x16x32_f16 v[36:39], v[76:79], v[224:227], v[36:39]
    ds_read_b128 v[124:127], v27 offset:3792
    v_mfma_f32_16x16x32_f16 v[40:43], v[76:79], v[232:235], v[40:43]
    v_mfma_f32_16x16x32_f16 v[40:43], v[188:191], v[84:87], v[40:43]
    s_waitcnt lgkmcnt(4)
    v_mfma_f32_16x16x32_f16 v[36:39], v[152:155], v[104:107], v[36:39]
    v_cvt_pk_f16_f32 v72, v59, v63
    v_cvt_pk_f16_f32 v73, v58, v62
    v_mfma_f32_16x16x32_f16 v[40:43], v[184:187], v[104:107], v[40:43]
    s_waitcnt lgkmcnt(3)
    v_cvt_pk_f16_f32 v74, v57, v61
    v_cvt_pk_f16_f32 v75, v56, v60
    v_mfma_f32_16x16x32_f16 v[64:67], v[108:111], v[196:199], 0
    ds_read_b128 v[120:123], v25 offset:4384
    v_cvt_pk_f16_f32 v32, v32, v33
    v_mfma_f32_16x16x32_f16 v[68:71], v[108:111], v[200:203], 0
    v_cvt_pk_f16_f32 v33, v34, v35
    v_mfma_f32_16x16x32_f16 v[36:39], v[72:75], v[240:243], v[36:39]
    ds_read_b128 v[80:83], v25 offset:4448
    v_mfma_f32_16x16x32_f16 v[40:43], v[72:75], v[244:247], v[40:43]
    s_waitcnt lgkmcnt(4)
    ds_read_b128 v[88:91], v25 offset:3040
    v_mfma_f32_16x16x32_f16 v[36:39], v[148:151], v[112:115], v[36:39]
    v_mfma_f32_16x16x32_f16 v[40:43], v[180:183], v[112:115], v[40:43]
    s_waitcnt lgkmcnt(4)
    ds_read_b128 v[92:95], v25 offset:3024
    v_cvt_pk_f16_f32 v76, v67, v71
    v_mfma_f32_16x16x32_f16 v[36:39], v[144:147], v[116:119], v[36:39]
    s_waitcnt lgkmcnt(4)
    v_cvt_pk_f16_f32 v77, v66, v70
    v_cvt_pk_f16_f32 v78, v65, v69
    v_mfma_f32_16x16x32_f16 v[56:59], v[124:127], v[196:199], 0
    v_cvt_pk_f16_f32 v79, v64, v68
    v_mfma_f32_16x16x32_f16 v[60:63], v[124:127], v[200:203], 0
    s_nop 0
    v_mfma_f32_16x16x32_f16 v[36:39], v[76:79], v[220:223], v[36:39]
    ds_read_b128 v[96:99], v25 offset:4512
    v_mfma_f32_16x16x32_f16 v[40:43], v[76:79], v[228:231], v[40:43]
    v_mfma_f32_16x16x32_f16 v[40:43], v[176:179], v[116:119], v[40:43]
    s_waitcnt lgkmcnt(4)
    ds_read_b32 v52, v12 offset:16
    ds_read_b128 v[100:103], v27 offset:4048
    v_mfma_f32_16x16x32_f16 v[36:39], v[140:143], v[120:123], v[36:39]
    ds_read_b64 v[8:9], v5 offset:2560
    v_cvt_pk_f16_f32 v72, v59, v63
    v_mfma_f32_16x16x32_f16 v[40:43], v[172:175], v[120:123], v[40:43]
    s_waitcnt lgkmcnt(6)
    ds_read_b64 v[10:11], v5 offset:3072
    v_cvt_pk_f16_f32 v73, v58, v62
    v_mfma_f32_16x16x32_f16 v[36:39], v[136:139], v[80:83], v[36:39]
    s_waitcnt lgkmcnt(6)
    ds_read_b64 v[18:19], v5 offset:3584
    v_cvt_pk_f16_f32 v74, v57, v61
    v_mfma_f32_16x16x32_f16 v[64:67], v[88:91], v[208:211], 0
    ds_read_b128 v[84:87], v25 offset:4576
    v_cvt_pk_f16_f32 v75, v56, v60
    v_mfma_f32_16x16x32_f16 v[40:43], v[212:215], v[88:91], v[40:43]
    s_waitcnt lgkmcnt(7)
    ds_read_b128 v[104:107], v25 offset:4640
    v_mfma_f32_16x16x32_f16 v[68:71], v[92:95], v[204:207], 0
    ds_read_b128 v[108:111], v27 offset:4304
    v_mfma_f32_16x16x32_f16 v[36:39], v[72:75], v[216:219], v[36:39]
    s_waitcnt lgkmcnt(3)
    v_cmp_ne_u32 vcc, 1, v52
    s_cbranch_vccnz L_g12
L_g12r:
    v_mfma_f32_16x16x32_f16 v[40:43], v[72:75], v[224:227], v[40:43]
    v_pk_mul_f16 v32, v32, v8
    v_pk_mul_f16 v33, v33, v9
    v_mfma_f32_16x16x32_f16 v[40:43], v[168:171], v[80:83], v[40:43]
    ds_read_b128 v[112:115], v25 offset:4704
    v_cvt_pk_f16_f32 v76, v67, v71
    v_mfma_f32_16x16x32_f16 v[36:39], v[132:135], v[96:99], v[36:39]
    ds_read_b128 v[124:127], v25 offset:4768
    v_cvt_pk_f16_f32 v77, v66, v70
    v_mfma_f32_16x16x32_f16 v[40:43], v[164:167], v[96:99], v[40:43]
    ds_read_b128 v[116:119], v25 offset:4832
    v_cvt_pk_f16_f32 v78, v65, v69
    v_mfma_f32_16x16x32_f16 v[56:59], v[100:103], v[196:199], 0
    v_cvt_pk_f16_f32 v79, v64, v68
    v_add_u32 v32, 0x00040004, v32
    v_mfma_f32_16x16x32_f16 v[60:63], v[100:103], v[200:203], 0
    ds_read_b128 v[120:123], v25 offset:4896
    v_add_u32 v33, 0x00040004, v33
    v_mfma_f32_16x16x32_f16 v[40:43], v[76:79], v[240:243], v[40:43]
    s_waitcnt lgkmcnt(6)
    ds_read_b128 v[88:91], v25 offset:4960
    v_and_or_b32 v32, v32, v13, v17
    v_mfma_f32_16x16x32_f16 v[36:39], v[128:131], v[84:87], v[36:39]
    ds_read_b128 v[92:95], v25 offset:5024
    v_cvt_pk_f16_f32 v72, v59, v63
    v_mfma_f32_16x16x32_f16 v[40:43], v[160:163], v[84:87], v[40:43]
    s_waitcnt lgkmcnt(7)
    ds_read_b128 v[80:83], v25 offset:5088
    v_cvt_pk_f16_f32 v73, v58, v62
    v_mfma_f32_16x16x32_f16 v[40:43], v[156:159], v[104:107], v[40:43]
    s_waitcnt lgkmcnt(7)
    v_cvt_pk_f16_f32 v74, v57, v61
    v_cvt_pk_f16_f32 v75, v56, v60
    v_mfma_f32_16x16x32_f16 v[64:67], v[108:111], v[196:199], 0
    v_and_or_b32 v33, v33, v13, v2
    v_cvt_pk_f16_f32 v36, v36, v37
    v_mfma_f32_16x16x32_f16 v[68:71], v[108:111], v[200:203], 0
    v_cvt_pk_f16_f32 v37, v38, v39
    v_pk_mul_f16 v36, v36, v10
    v_mfma_f32_16x16x32_f16 v[40:43], v[72:75], v[220:223], v[40:43]
    s_waitcnt lgkmcnt(6)
    v_pk_mul_f16 v37, v37, v11
    v_add_u32 v36, 0x00040004, v36
    v_mfma_f32_16x16x32_f16 v[40:43], v[152:155], v[112:115], v[40:43]
    s_waitcnt lgkmcnt(5)
    v_cvt_pk_f16_f32 v76, v67, v71
    v_cvt_pk_f16_f32 v77, v66, v70
    v_mfma_f32_16x16x32_f16 v[40:43], v[148:151], v[124:127], v[40:43]
    s_waitcnt lgkmcnt(4)
    v_cvt_pk_f16_f32 v78, v65, v69
    v_cvt_pk_f16_f32 v79, v64, v68
    v_mfma_f32_16x16x32_f16 v[40:43], v[144:147], v[116:119], v[40:43]
    s_waitcnt lgkmcnt(3)
    v_add_u32 v37, 0x00040004, v37
    v_and_or_b32 v34, v36, v13, v17
    v_mfma_f32_16x16x32_f16 v[40:43], v[140:143], v[120:123], v[40:43]
    s_waitcnt lgkmcnt(2)
    v_and_or_b32 v35, v37, v13, v2
    v_mfma_f32_16x16x32_f16 v[40:43], v[136:139], v[88:91], v[40:43]
    s_xor_b32 s5, s58, 163840
    v_permlane16_swap_b32 v32, v34
    v_mfma_f32_16x16x32_f16 v[40:43], v[76:79], v[216:219], v[40:43]
    s_waitcnt lgkmcnt(1)
    v_permlane16_swap_b32 v33, v35
    v_mfma_f32_16x16x32_f16 v[40:43], v[132:135], v[92:95], v[40:43]
    s_waitcnt lgkmcnt(0)
    buffer_store_dwordx4 v[32:35], v7, s[40:43], s5 offen
    v_mfma_f32_16x16x32_f16 v[40:43], v[128:131], v[80:83], v[40:43]
    ds_add_u32 v4, v6 offset:116
    s_nop 6
    v_cvt_pk_f16_f32 v40, v40, v41
    v_cvt_pk_f16_f32 v41, v42, v43
    v_pk_mul_f16 v40, v40, v18
    v_pk_mul_f16 v41, v41, v19
    v_add_u32 v40, 0x00040004, v40
    v_add_u32 v41, 0x00040004, v41
    v_and_or_b32 v40, v40, v13, v17
    v_and_or_b32 v41, v41, v13, v2
    s_xor_b32 s5, s58, 229376
    v_permlane16_swap_b32 v40, v42
    v_permlane16_swap_b32 v41, v43
    buffer_store_dwordx4 v[40:43], v26, s[40:43], s5 offen
    ds_add_u32 v4, v6 offset:124
    s_cmp_eq_u32 s61, 0
    s_cbranch_scc1 L_last
    v_xor_b32 v26, 0x20000000, v26
    v_xor_b32 v7, 0x20000000, v7
    s_xor_b32 s5, s58, 163840
    buffer_store_dwordx4 v[32:35], v7, s[40:43], s5 offen sc1
    s_xor_b32 s5, s58, 229376
    buffer_store_dwordx4 v[40:43], v26, s[40:43], s5 offen sc1
    s_endpgm
L_g12:
    ds_read_b32 v52, v12 offset:16
    ds_read_b64 v[8:9], v5 offset:2560
    ds_read_b64 v[10:11], v5 offset:3072
    ds_read_b64 v[18:19], v5 offset:3584
    s_add_u32 s75, s75, 1
    s_cmp_ge_u32 s75, 1920000
    s_waitcnt lgkmcnt(0)
    s_cbranch_scc1 L_g12r
    v_cmp_eq_u32 vcc, 0, v52
    s_cbranch_vccnz L_g12
    v_cmp_eq_u32 vcc, 1, v52
    s_cbranch_vccnz L_g12r
    s_mov_b32 s61, 1
    v_xor_b32 v26, 0x20000000, v26
    v_xor_b32 v7, 0x20000000, v7
    s_branch L_g12r
L_last:
    s_endpgm
.section .rodata,"a"
.p2align 6
.amdhsa_kernel recurrent_scan__ssm_conv_s4__moe_arch_mod__prompt_kernel
  .amdhsa_next_free_vgpr 256
  .amdhsa_next_free_sgpr 102
  .amdhsa_accum_offset 256
  .amdhsa_group_segment_fixed_size 0
  .amdhsa_kernarg_size 136
  .amdhsa_user_sgpr_count 2
  .amdhsa_user_sgpr_kernarg_segment_ptr 1
  .amdhsa_system_sgpr_workgroup_id_x 1
.end_amdhsa_kernel
```
